```python
import torch

def _softmax(x, axis=-1):
    return torch.softmax(x, dim=axis)
def _gelu(x):
    return torch.nn.functional.gelu(x, approximate="tanh")
def _silu(x):
    return torch.nn.functional.silu(x)
def _sigmoid(x):
    return torch.sigmoid(x)
def _layernorm(x, axis=-1, eps=1e-5):
    m = x.mean(dim=axis, keepdim=True)
    v = x.var(dim=axis, keepdim=True, unbiased=False)
    return (x - m) / torch.sqrt(v + eps)
def _scatter_add(tgt, idx, src, axis=0):
    return tgt.clone().index_add_(axis, idx, src)
def _segment_sum(src, seg, n):
    out = torch.zeros((n,) + src.shape[1:], dtype=src.dtype)
    return out.index_add_(0, seg, src)
def _pad(x, pw):
    flat = tuple(v for pair in reversed(pw) for v in pair)
    return torch.nn.functional.pad(x, flat)

kernel_name = 'parallel_sum__spectral_fnet__geglu_ffn__prompt'

def setup_inputs():

    _w = (lambda a: (lambda t: t.to(torch.bfloat16) if t.is_floating_point() else t)(torch.as_tensor(a)))
    def _A_setup():
        B, S, D = 1, 2048, 512
        ns = torch.arange(S)[:, None] * torch.arange(S)[None, :]
        nd = torch.arange(D)[:, None] * torch.arange(D)[None, :]
        Ws_re = torch.cos(-2.0 * torch.pi * ns / S).to(float)
        Ws_im = torch.sin(-2.0 * torch.pi * ns / S).to(float)
        Wd_re = torch.cos(-2.0 * torch.pi * nd / D).to(float)
        Wd_im = torch.sin(-2.0 * torch.pi * nd / D).to(float)
        return {
            "x": _w((lambda *s: torch.randn(*s, dtype=torch.bfloat16) * 0.05)(B, S, D)),
            "dft_seq_re": _w(Ws_re),
            "dft_seq_im": _w(Ws_im),
            "dft_hid_re": _w(Wd_re),
            "dft_hid_im": _w(Wd_im),
        }
    _A_in = _A_setup()

    def _B_setup():
        B, S, D, F = 1, 2048, 512, 1376
        return {
            "x": _w((lambda *s: torch.randn(*s, dtype=torch.bfloat16) * 0.05)(B, S, D)),
            "w_gate": _w((lambda *s: torch.randn(*s, dtype=torch.bfloat16) * 0.2)(D, F)),
            "w_up": _w((lambda *s: torch.randn(*s, dtype=torch.bfloat16) * 0.2)(D, F)),
            "w_down": _w((lambda *s: torch.randn(*s, dtype=torch.bfloat16) * 0.2)(F, D)),
        }
    _B_in = _B_setup()

    return {
        "A_x": _A_in["x"],
        "A_dft_seq_re": _A_in["dft_seq_re"],
        "A_dft_seq_im": _A_in["dft_seq_im"],
        "A_dft_hid_re": _A_in["dft_hid_re"],
        "A_dft_hid_im": _A_in["dft_hid_im"],
        "B_x": _B_in["x"],
        "B_w_gate": _B_in["w_gate"],
        "B_w_up": _B_in["w_up"],
        "B_w_down": _B_in["w_down"],
    }

def reference(A_x, A_dft_seq_re, A_dft_seq_im, A_dft_hid_re, A_dft_hid_im, B_x, B_w_gate, B_w_up, B_w_down):
    def _A_ref(x, dft_seq_re, dft_seq_im, dft_hid_re, dft_hid_im):
        a = torch.einsum("bsd,ed->bse", x, dft_hid_re)
        b = torch.einsum("bsd,ed->bse", x, dft_hid_im)
        y = torch.einsum("ts,bse->bte", dft_seq_re, a) - torch.einsum("ts,bse->bte", dft_seq_im, b)
        return y

    def _B_ref(x, w_gate, w_up, w_down):
        return (_gelu(x @ w_gate) * (x @ w_up)) @ w_down

    x = A_x
    xn = _layernorm(x, axis=-1)
    return x + _A_ref(xn, A_dft_seq_re, A_dft_seq_im, A_dft_hid_re, A_dft_hid_im) + _B_ref(xn, B_w_gate, B_w_up, B_w_down)
```

```asm
; @launch kernel=prep_kernel grid=(404,1,1) block=(256,1,1) lds=16384
; @launch kernel=stage1_kernel grid=(256,1,1) block=(512,1,1) lds=163840
; @launch kernel=stage2_kernel grid=(256,1,1) block=(512,1,1) lds=163840
.amdgcn_target "amdgcn-amd-amdhsa--gfx950"
.text
.p2align 8
.globl prep_kernel
.type prep_kernel,@function
prep_kernel:
s_cmp_ge_u32 s2, 404
s_cbranch_scc1 L_prep_done
s_load_dwordx2 s[4:5], s[0:1], 88
v_and_b32 v1, 63, v0
v_lshrrev_b32 v2, 6, v0
s_nop 0
v_readfirstlane_b32 s3, v2
s_nop 3
s_cmp_lt_u32 s2, 256
s_cbranch_scc1 L_prep_ln
s_cmp_lt_u32 s2, 344
s_cbranch_scc1 L_prep_tr
s_cmp_lt_u32 s2, 360
s_cbranch_scc1 L_prep_copy
s_load_dwordx2 s[6:7], s[0:1], 48
s_load_dwordx2 s[26:27], s[0:1], 56
s_sub_u32 s20, s2, 360
s_cmp_ge_u32 s20, 22
s_cselect_b32 s21, 22, 0
s_sub_u32 s20, s20, s21
s_waitcnt lgkmcnt(0)
s_cmp_eq_u32 s21, 22
s_cselect_b32 s6, s26, s6
s_cselect_b32 s7, s27, s7
s_mov_b32 s8, s6
s_and_b32 s9, s7, 0xffff
s_mov_b32 s10, 1409024
s_mov_b32 s11, 0x00020000
s_lshl_b32 s22, s20, 16
s_lshl_b32 s23, s3, 14
s_add_u32 s22, s22, s23
v_lshlrev_b32 v3, 4, v1
buffer_load_dwordx4 v[16:19], v3, s[8:11], s22 offen offset:0
buffer_load_dwordx4 v[20:23], v3, s[8:11], s22 offen offset:1024
buffer_load_dwordx4 v[24:27], v3, s[8:11], s22 offen offset:2048
buffer_load_dwordx4 v[28:31], v3, s[8:11], s22 offen offset:3072
s_add_u32 s22, s22, 4096
buffer_load_dwordx4 v[32:35], v3, s[8:11], s22 offen offset:0
buffer_load_dwordx4 v[36:39], v3, s[8:11], s22 offen offset:1024
buffer_load_dwordx4 v[40:43], v3, s[8:11], s22 offen offset:2048
buffer_load_dwordx4 v[44:47], v3, s[8:11], s22 offen offset:3072
s_add_u32 s22, s22, 4096
buffer_load_dwordx4 v[48:51], v3, s[8:11], s22 offen offset:0
buffer_load_dwordx4 v[52:55], v3, s[8:11], s22 offen offset:1024
buffer_load_dwordx4 v[56:59], v3, s[8:11], s22 offen offset:2048
buffer_load_dwordx4 v[60:63], v3, s[8:11], s22 offen offset:3072
s_add_u32 s22, s22, 4096
buffer_load_dwordx4 v[64:67], v3, s[8:11], s22 offen offset:0
buffer_load_dwordx4 v[68:71], v3, s[8:11], s22 offen offset:1024
buffer_load_dwordx4 v[72:75], v3, s[8:11], s22 offen offset:2048
buffer_load_dwordx4 v[76:79], v3, s[8:11], s22 offen offset:3072
s_add_u32 s22, s22, 4096
s_endpgm
L_prep_ln:
s_load_dwordx2 s[6:7], s[0:1], 0
s_waitcnt lgkmcnt(0)
s_mov_b32 s8, s6
s_and_b32 s9, s7, 0xffff
s_mov_b32 s10, 2097152
s_mov_b32 s11, 0x00020000
s_add_u32 s24, s4, 0
s_addc_u32 s25, s5, 0
s_mov_b32 s12, s24
s_and_b32 s13, s25, 0xffff
s_mov_b32 s14, 2097152
s_mov_b32 s15, 0x00020000
s_lshl_b32 s20, s2, 13
s_lshl_b32 s22, s3, 11
s_add_u32 s20, s20, s22
v_lshlrev_b32 v3, 4, v1
buffer_load_dwordx4 v[16:19], v3, s[8:11], s20 offen offset:0
buffer_load_dwordx4 v[20:23], v3, s[8:11], s20 offen offset:1024
s_waitcnt vmcnt(1)
v_lshlrev_b32 v32, 16, v16
v_and_b32 v33, 0xffff0000, v16
v_lshlrev_b32 v34, 16, v17
v_and_b32 v35, 0xffff0000, v17
v_lshlrev_b32 v36, 16, v18
v_and_b32 v37, 0xffff0000, v18
v_lshlrev_b32 v38, 16, v19
v_and_b32 v39, 0xffff0000, v19
s_waitcnt vmcnt(0)
v_lshlrev_b32 v40, 16, v20
v_and_b32 v41, 0xffff0000, v20
v_lshlrev_b32 v42, 16, v21
v_and_b32 v43, 0xffff0000, v21
v_lshlrev_b32 v44, 16, v22
v_and_b32 v45, 0xffff0000, v22
v_lshlrev_b32 v46, 16, v23
v_and_b32 v47, 0xffff0000, v23
v_add_f32 v48, v32, v33
v_add_f32 v49, v40, v41
v_add_f32 v48, v48, v34
v_add_f32 v49, v49, v42
v_add_f32 v48, v48, v35
v_add_f32 v49, v49, v43
v_add_f32 v48, v48, v36
v_add_f32 v49, v49, v44
v_add_f32 v48, v48, v37
v_add_f32 v49, v49, v45
v_add_f32 v48, v48, v38
v_add_f32 v49, v49, v46
v_add_f32 v48, v48, v39
v_add_f32 v49, v49, v47
s_nop 0
v_add_f32_dpp v48, v48, v48 row_shr:1 row_mask:0xf bank_mask:0xf bound_ctrl:0
v_add_f32_dpp v49, v49, v49 row_shr:1 row_mask:0xf bank_mask:0xf bound_ctrl:0
s_nop 0
v_add_f32_dpp v48, v48, v48 row_shr:2 row_mask:0xf bank_mask:0xf bound_ctrl:0
v_add_f32_dpp v49, v49, v49 row_shr:2 row_mask:0xf bank_mask:0xf bound_ctrl:0
s_nop 0
v_add_f32_dpp v48, v48, v48 row_shr:4 row_mask:0xf bank_mask:0xf bound_ctrl:0
v_add_f32_dpp v49, v49, v49 row_shr:4 row_mask:0xf bank_mask:0xf bound_ctrl:0
s_nop 0
v_add_f32_dpp v48, v48, v48 row_shr:8 row_mask:0xf bank_mask:0xf bound_ctrl:0
v_add_f32_dpp v49, v49, v49 row_shr:8 row_mask:0xf bank_mask:0xf bound_ctrl:0
s_nop 0
v_add_f32_dpp v48, v48, v48 row_bcast:15 row_mask:0xa bank_mask:0xf
v_add_f32_dpp v49, v49, v49 row_bcast:15 row_mask:0xa bank_mask:0xf
s_nop 0
v_add_f32_dpp v48, v48, v48 row_bcast:31 row_mask:0xc bank_mask:0xf
v_add_f32_dpp v49, v49, v49 row_bcast:31 row_mask:0xc bank_mask:0xf
s_nop 0
v_readlane_b32 s32, v48, 63
v_readlane_b32 s33, v49, 63
s_nop 1
v_mov_b32 v52, s32
v_mov_b32 v53, s33
v_mul_f32 v52, 0x3b000000, v52
v_mul_f32 v53, 0x3b000000, v53
v_sub_f32 v56, v32, v52
v_sub_f32 v57, v40, v53
v_mul_f32 v48, v56, v56
v_mul_f32 v49, v57, v57
v_sub_f32 v56, v33, v52
v_sub_f32 v57, v41, v53
v_fmac_f32 v48, v56, v56
v_fmac_f32 v49, v57, v57
v_sub_f32 v56, v34, v52
v_sub_f32 v57, v42, v53
v_fmac_f32 v48, v56, v56
v_fmac_f32 v49, v57, v57
v_sub_f32 v56, v35, v52
v_sub_f32 v57, v43, v53
v_fmac_f32 v48, v56, v56
v_fmac_f32 v49, v57, v57
v_sub_f32 v56, v36, v52
v_sub_f32 v57, v44, v53
v_fmac_f32 v48, v56, v56
v_fmac_f32 v49, v57, v57
v_sub_f32 v56, v37, v52
v_sub_f32 v57, v45, v53
v_fmac_f32 v48, v56, v56
v_fmac_f32 v49, v57, v57
v_sub_f32 v56, v38, v52
v_sub_f32 v57, v46, v53
v_fmac_f32 v48, v56, v56
v_fmac_f32 v49, v57, v57
v_sub_f32 v56, v39, v52
v_sub_f32 v57, v47, v53
v_fmac_f32 v48, v56, v56
v_fmac_f32 v49, v57, v57
s_nop 0
v_add_f32_dpp v48, v48, v48 row_shr:1 row_mask:0xf bank_mask:0xf bound_ctrl:0
v_add_f32_dpp v49, v49, v49 row_shr:1 row_mask:0xf bank_mask:0xf bound_ctrl:0
s_nop 0
v_add_f32_dpp v48, v48, v48 row_shr:2 row_mask:0xf bank_mask:0xf bound_ctrl:0
v_add_f32_dpp v49, v49, v49 row_shr:2 row_mask:0xf bank_mask:0xf bound_ctrl:0
s_nop 0
v_add_f32_dpp v48, v48, v48 row_shr:4 row_mask:0xf bank_mask:0xf bound_ctrl:0
v_add_f32_dpp v49, v49, v49 row_shr:4 row_mask:0xf bank_mask:0xf bound_ctrl:0
s_nop 0
v_add_f32_dpp v48, v48, v48 row_shr:8 row_mask:0xf bank_mask:0xf bound_ctrl:0
v_add_f32_dpp v49, v49, v49 row_shr:8 row_mask:0xf bank_mask:0xf bound_ctrl:0
s_nop 0
v_add_f32_dpp v48, v48, v48 row_bcast:15 row_mask:0xa bank_mask:0xf
v_add_f32_dpp v49, v49, v49 row_bcast:15 row_mask:0xa bank_mask:0xf
s_nop 0
v_add_f32_dpp v48, v48, v48 row_bcast:31 row_mask:0xc bank_mask:0xf
v_add_f32_dpp v49, v49, v49 row_bcast:31 row_mask:0xc bank_mask:0xf
s_nop 0
v_readlane_b32 s32, v48, 63
v_readlane_b32 s33, v49, 63
s_nop 1
v_mov_b32 v56, s32
v_mov_b32 v57, s33
v_mul_f32 v56, 0x3b000000, v56
v_mul_f32 v57, 0x3b000000, v57
v_cvt_pk_bf16_f32 v60, v56, v52
v_cvt_pk_bf16_f32 v61, v57, v53
v_lshlrev_b32 v56, 16, v60
v_and_b32 v52, 0xffff0000, v60
v_lshlrev_b32 v57, 16, v61
v_and_b32 v53, 0xffff0000, v61
v_add_f32 v56, 0x3727c5ac, v56
v_add_f32 v57, 0x3727c5ac, v57
v_cvt_pk_bf16_f32 v60, v56, v56
v_cvt_pk_bf16_f32 v61, v57, v57
v_lshlrev_b32 v56, 16, v60
v_lshlrev_b32 v57, 16, v61
v_sqrt_f32 v56, v56
v_sqrt_f32 v57, v57
s_nop 0
v_cvt_pk_bf16_f32 v60, v56, v56
v_cvt_pk_bf16_f32 v61, v57, v57
v_lshlrev_b32 v56, 16, v60
v_lshlrev_b32 v57, 16, v61
v_rcp_f32 v64, v56
v_rcp_f32 v65, v57
s_nop 0
v_sub_f32 v32, v32, v52
v_sub_f32 v33, v33, v52
v_cvt_pk_bf16_f32 v4, v32, v33
v_lshlrev_b32 v32, 16, v4
v_and_b32 v33, 0xffff0000, v4
v_mul_f32 v5, v32, v64
v_mul_f32 v6, v33, v64
v_fma_f32 v7, -v5, v56, v32
v_fma_f32 v8, -v6, v56, v33
v_fma_f32 v5, v7, v64, v5
v_fma_f32 v6, v8, v64, v6
v_cvt_pk_bf16_f32 v16, v5, v6
v_sub_f32 v34, v34, v52
v_sub_f32 v35, v35, v52
v_cvt_pk_bf16_f32 v4, v34, v35
v_lshlrev_b32 v34, 16, v4
v_and_b32 v35, 0xffff0000, v4
v_mul_f32 v5, v34, v64
v_mul_f32 v6, v35, v64
v_fma_f32 v7, -v5, v56, v34
v_fma_f32 v8, -v6, v56, v35
v_fma_f32 v5, v7, v64, v5
v_fma_f32 v6, v8, v64, v6
v_cvt_pk_bf16_f32 v17, v5, v6
v_sub_f32 v36, v36, v52
v_sub_f32 v37, v37, v52
v_cvt_pk_bf16_f32 v4, v36, v37
v_lshlrev_b32 v36, 16, v4
v_and_b32 v37, 0xffff0000, v4
v_mul_f32 v5, v36, v64
v_mul_f32 v6, v37, v64
v_fma_f32 v7, -v5, v56, v36
v_fma_f32 v8, -v6, v56, v37
v_fma_f32 v5, v7, v64, v5
v_fma_f32 v6, v8, v64, v6
v_cvt_pk_bf16_f32 v18, v5, v6
v_sub_f32 v38, v38, v52
v_sub_f32 v39, v39, v52
v_cvt_pk_bf16_f32 v4, v38, v39
v_lshlrev_b32 v38, 16, v4
v_and_b32 v39, 0xffff0000, v4
v_mul_f32 v5, v38, v64
v_mul_f32 v6, v39, v64
v_fma_f32 v7, -v5, v56, v38
v_fma_f32 v8, -v6, v56, v39
v_fma_f32 v5, v7, v64, v5
v_fma_f32 v6, v8, v64, v6
v_cvt_pk_bf16_f32 v19, v5, v6
v_sub_f32 v40, v40, v53
v_sub_f32 v41, v41, v53
v_cvt_pk_bf16_f32 v4, v40, v41
v_lshlrev_b32 v40, 16, v4
v_and_b32 v41, 0xffff0000, v4
v_mul_f32 v5, v40, v65
v_mul_f32 v6, v41, v65
v_fma_f32 v7, -v5, v57, v40
v_fma_f32 v8, -v6, v57, v41
v_fma_f32 v5, v7, v65, v5
v_fma_f32 v6, v8, v65, v6
v_cvt_pk_bf16_f32 v20, v5, v6
v_sub_f32 v42, v42, v53
v_sub_f32 v43, v43, v53
v_cvt_pk_bf16_f32 v4, v42, v43
v_lshlrev_b32 v42, 16, v4
v_and_b32 v43, 0xffff0000, v4
v_mul_f32 v5, v42, v65
v_mul_f32 v6, v43, v65
v_fma_f32 v7, -v5, v57, v42
v_fma_f32 v8, -v6, v57, v43
v_fma_f32 v5, v7, v65, v5
v_fma_f32 v6, v8, v65, v6
v_cvt_pk_bf16_f32 v21, v5, v6
v_sub_f32 v44, v44, v53
v_sub_f32 v45, v45, v53
v_cvt_pk_bf16_f32 v4, v44, v45
v_lshlrev_b32 v44, 16, v4
v_and_b32 v45, 0xffff0000, v4
v_mul_f32 v5, v44, v65
v_mul_f32 v6, v45, v65
v_fma_f32 v7, -v5, v57, v44
v_fma_f32 v8, -v6, v57, v45
v_fma_f32 v5, v7, v65, v5
v_fma_f32 v6, v8, v65, v6
v_cvt_pk_bf16_f32 v22, v5, v6
v_sub_f32 v46, v46, v53
v_sub_f32 v47, v47, v53
v_cvt_pk_bf16_f32 v4, v46, v47
v_lshlrev_b32 v46, 16, v4
v_and_b32 v47, 0xffff0000, v4
v_mul_f32 v5, v46, v65
v_mul_f32 v6, v47, v65
v_fma_f32 v7, -v5, v57, v46
v_fma_f32 v8, -v6, v57, v47
v_fma_f32 v5, v7, v65, v5
v_fma_f32 v6, v8, v65, v6
v_cvt_pk_bf16_f32 v23, v5, v6
buffer_store_dwordx4 v[16:19], v3, s[12:15], s20 offen offset:0
buffer_store_dwordx4 v[20:23], v3, s[12:15], s20 offen offset:1024
s_endpgm
L_prep_tr:
s_load_dwordx2 s[28:29], s[0:1], 64
s_sub_u32 s20, s2, 256
s_waitcnt lgkmcnt(0)
s_lshr_b32 s22, s20, 2
s_and_b32 s23, s20, 3
s_mov_b32 s8, s28
s_and_b32 s9, s29, 0xffff
s_mov_b32 s10, 1409024
s_mov_b32 s11, 0x00020000
s_add_u32 s24, s4, 2097152
s_addc_u32 s25, s5, 0
s_mov_b32 s12, s24
s_and_b32 s13, s25, 0xffff
s_mov_b32 s14, 2490368
s_mov_b32 s15, 0x00020000
v_lshrrev_b32 v3, 4, v1
v_and_b32 v4, 15, v1
v_lshlrev_b32 v5, 10, v3
v_lshlrev_b32 v6, 4, v4
v_add_u32 v5, v5, v6
s_lshl_b32 s24, s22, 6
s_lshl_b32 s25, s3, 4
s_add_u32 s24, s24, s25
s_lshl_b32 s24, s24, 10
s_lshl_b32 s25, s23, 8
s_add_u32 s24, s24, s25
v_and_b32 v8, 127, v0
s_lshl_b32 s31, s23, 7
v_add_u32 v8, s31, v8
s_movk_i32 s25, 4864
v_mul_lo_u32 v8, v8, s25
s_lshl_b32 s31, s22, 7
s_add_u32 s31, s31, 2048
buffer_load_dwordx4 v[16:19], v5, s[8:11], s24 offen
s_add_u32 s24, s24, 4096
buffer_load_dwordx4 v[20:23], v5, s[8:11], s24 offen
s_add_u32 s24, s24, 4096
buffer_load_dwordx4 v[24:27], v5, s[8:11], s24 offen
s_add_u32 s24, s24, 4096
buffer_load_dwordx4 v[28:31], v5, s[8:11], s24 offen
s_add_u32 s24, s24, 4096
v_lshlrev_b32 v9, 12, v2
v_lshlrev_b32 v10, 4, v1
v_add_u32 v9, v9, v10
v_lshrrev_b32 v10, 7, v0
v_lshlrev_b32 v11, 6, v10
v_add_u32 v8, v8, v11
v_lshlrev_b32 v10, 13, v10
v_and_b32 v11, 127, v0
v_lshlrev_b32 v11, 1, v11
v_add_u32 v10, v10, v11
s_waitcnt vmcnt(3)
ds_write_b128 v9, v[16:19] offset:0
s_waitcnt vmcnt(2)
ds_write_b128 v9, v[20:23] offset:1024
s_waitcnt vmcnt(1)
ds_write_b128 v9, v[24:27] offset:2048
s_waitcnt vmcnt(0)
ds_write_b128 v9, v[28:31] offset:3072
s_waitcnt lgkmcnt(0)
s_barrier
ds_read_u16 v32, v10 offset:0
ds_read_u16 v33, v10 offset:256
ds_read_u16 v34, v10 offset:512
ds_read_u16 v35, v10 offset:768
ds_read_u16 v36, v10 offset:1024
ds_read_u16 v37, v10 offset:1280
ds_read_u16 v38, v10 offset:1536
ds_read_u16 v39, v10 offset:1792
ds_read_u16 v40, v10 offset:2048
ds_read_u16 v41, v10 offset:2304
ds_read_u16 v42, v10 offset:2560
ds_read_u16 v43, v10 offset:2816
ds_read_u16 v44, v10 offset:3072
ds_read_u16 v45, v10 offset:3328
ds_read_u16 v46, v10 offset:3584
ds_read_u16 v47, v10 offset:3840
ds_read_u16 v48, v10 offset:4096
ds_read_u16 v49, v10 offset:4352
ds_read_u16 v50, v10 offset:4608
ds_read_u16 v51, v10 offset:4864
ds_read_u16 v52, v10 offset:5120
ds_read_u16 v53, v10 offset:5376
ds_read_u16 v54, v10 offset:5632
ds_read_u16 v55, v10 offset:5888
ds_read_u16 v56, v10 offset:6144
ds_read_u16 v57, v10 offset:6400
ds_read_u16 v58, v10 offset:6656
ds_read_u16 v59, v10 offset:6912
ds_read_u16 v60, v10 offset:7168
ds_read_u16 v61, v10 offset:7424
ds_read_u16 v62, v10 offset:7680
ds_read_u16 v63, v10 offset:7936
s_waitcnt lgkmcnt(15)
v_lshl_or_b32 v32, v33, 16, v32
v_lshl_or_b32 v33, v35, 16, v34
v_lshl_or_b32 v34, v37, 16, v36
v_lshl_or_b32 v35, v39, 16, v38
buffer_store_dwordx4 v[32:35], v8, s[12:15], s31 offen offset:0
s_waitcnt lgkmcnt(15)
v_lshl_or_b32 v36, v41, 16, v40
v_lshl_or_b32 v37, v43, 16, v42
v_lshl_or_b32 v38, v45, 16, v44
v_lshl_or_b32 v39, v47, 16, v46
buffer_store_dwordx4 v[36:39], v8, s[12:15], s31 offen offset:16
s_waitcnt lgkmcnt(8)
v_lshl_or_b32 v40, v49, 16, v48
v_lshl_or_b32 v41, v51, 16, v50
v_lshl_or_b32 v42, v53, 16, v52
v_lshl_or_b32 v43, v55, 16, v54
buffer_store_dwordx4 v[40:43], v8, s[12:15], s31 offen offset:32
s_waitcnt lgkmcnt(0)
v_lshl_or_b32 v44, v57, 16, v56
v_lshl_or_b32 v45, v59, 16, v58
v_lshl_or_b32 v46, v61, 16, v60
v_lshl_or_b32 v47, v63, 16, v62
buffer_store_dwordx4 v[44:47], v8, s[12:15], s31 offen offset:48
s_endpgm
L_prep_copy:
s_load_dwordx2 s[6:7], s[0:1], 24
s_load_dwordx2 s[26:27], s[0:1], 32
s_sub_u32 s20, s2, 344
s_lshr_b32 s21, s20, 3
s_and_b32 s20, s20, 7
s_waitcnt lgkmcnt(0)
s_cmp_eq_u32 s21, 1
s_cselect_b32 s6, s26, s6
s_cselect_b32 s7, s27, s7
s_cselect_b32 s28, 0x80008000, 0
s_mov_b32 s8, s6
s_and_b32 s9, s7, 0xffff
s_mov_b32 s10, 524288
s_mov_b32 s11, 0x00020000
s_add_u32 s24, s4, 2097152
s_addc_u32 s25, s5, 0
s_mov_b32 s12, s24
s_and_b32 s13, s25, 0xffff
s_mov_b32 s14, 2490368
s_mov_b32 s15, 0x00020000
s_lshl_b32 s22, s20, 6
s_add_u32 s22, s22, s3
s_lshl_b32 s23, s22, 10
s_mul_i32 s24, s22, 4864
s_lshl_b32 s25, s21, 10
s_add_u32 s24, s24, s25
v_lshlrev_b32 v3, 4, v1
buffer_load_dwordx4 v[16:19], v3, s[8:11], s23 offen
s_add_u32 s23, s23, 4096
buffer_load_dwordx4 v[20:23], v3, s[8:11], s23 offen
s_add_u32 s23, s23, 4096
buffer_load_dwordx4 v[24:27], v3, s[8:11], s23 offen
s_add_u32 s23, s23, 4096
buffer_load_dwordx4 v[28:31], v3, s[8:11], s23 offen
s_add_u32 s23, s23, 4096
buffer_load_dwordx4 v[32:35], v3, s[8:11], s23 offen
s_add_u32 s23, s23, 4096
buffer_load_dwordx4 v[36:39], v3, s[8:11], s23 offen
s_add_u32 s23, s23, 4096
buffer_load_dwordx4 v[40:43], v3, s[8:11], s23 offen
s_add_u32 s23, s23, 4096
buffer_load_dwordx4 v[44:47], v3, s[8:11], s23 offen
s_add_u32 s23, s23, 4096
buffer_load_dwordx4 v[48:51], v3, s[8:11], s23 offen
s_add_u32 s23, s23, 4096
buffer_load_dwordx4 v[52:55], v3, s[8:11], s23 offen
s_add_u32 s23, s23, 4096
buffer_load_dwordx4 v[56:59], v3, s[8:11], s23 offen
s_add_u32 s23, s23, 4096
buffer_load_dwordx4 v[60:63], v3, s[8:11], s23 offen
s_add_u32 s23, s23, 4096
buffer_load_dwordx4 v[64:67], v3, s[8:11], s23 offen
s_add_u32 s23, s23, 4096
buffer_load_dwordx4 v[68:71], v3, s[8:11], s23 offen
s_add_u32 s23, s23, 4096
buffer_load_dwordx4 v[72:75], v3, s[8:11], s23 offen
s_add_u32 s23, s23, 4096
buffer_load_dwordx4 v[76:79], v3, s[8:11], s23 offen
s_add_u32 s23, s23, 4096
s_waitcnt vmcnt(15)
v_xor_b32 v16, s28, v16
v_xor_b32 v17, s28, v17
v_xor_b32 v18, s28, v18
v_xor_b32 v19, s28, v19
buffer_store_dwordx4 v[16:19], v3, s[12:15], s24 offen
s_add_u32 s24, s24, 19456
s_waitcnt vmcnt(15)
v_xor_b32 v20, s28, v20
v_xor_b32 v21, s28, v21
v_xor_b32 v22, s28, v22
v_xor_b32 v23, s28, v23
buffer_store_dwordx4 v[20:23], v3, s[12:15], s24 offen
s_add_u32 s24, s24, 19456
s_waitcnt vmcnt(15)
v_xor_b32 v24, s28, v24
v_xor_b32 v25, s28, v25
v_xor_b32 v26, s28, v26
v_xor_b32 v27, s28, v27
buffer_store_dwordx4 v[24:27], v3, s[12:15], s24 offen
s_add_u32 s24, s24, 19456
s_waitcnt vmcnt(15)
v_xor_b32 v28, s28, v28
v_xor_b32 v29, s28, v29
v_xor_b32 v30, s28, v30
v_xor_b32 v31, s28, v31
buffer_store_dwordx4 v[28:31], v3, s[12:15], s24 offen
s_add_u32 s24, s24, 19456
s_waitcnt vmcnt(15)
v_xor_b32 v32, s28, v32
v_xor_b32 v33, s28, v33
v_xor_b32 v34, s28, v34
v_xor_b32 v35, s28, v35
buffer_store_dwordx4 v[32:35], v3, s[12:15], s24 offen
s_add_u32 s24, s24, 19456
s_waitcnt vmcnt(15)
v_xor_b32 v36, s28, v36
v_xor_b32 v37, s28, v37
v_xor_b32 v38, s28, v38
v_xor_b32 v39, s28, v39
buffer_store_dwordx4 v[36:39], v3, s[12:15], s24 offen
s_add_u32 s24, s24, 19456
s_waitcnt vmcnt(15)
v_xor_b32 v40, s28, v40
v_xor_b32 v41, s28, v41
v_xor_b32 v42, s28, v42
v_xor_b32 v43, s28, v43
buffer_store_dwordx4 v[40:43], v3, s[12:15], s24 offen
s_add_u32 s24, s24, 19456
s_waitcnt vmcnt(15)
v_xor_b32 v44, s28, v44
v_xor_b32 v45, s28, v45
v_xor_b32 v46, s28, v46
v_xor_b32 v47, s28, v47
buffer_store_dwordx4 v[44:47], v3, s[12:15], s24 offen
s_add_u32 s24, s24, 19456
s_waitcnt vmcnt(15)
v_xor_b32 v48, s28, v48
v_xor_b32 v49, s28, v49
v_xor_b32 v50, s28, v50
v_xor_b32 v51, s28, v51
buffer_store_dwordx4 v[48:51], v3, s[12:15], s24 offen
s_add_u32 s24, s24, 19456
s_waitcnt vmcnt(15)
v_xor_b32 v52, s28, v52
v_xor_b32 v53, s28, v53
v_xor_b32 v54, s28, v54
v_xor_b32 v55, s28, v55
buffer_store_dwordx4 v[52:55], v3, s[12:15], s24 offen
s_add_u32 s24, s24, 19456
s_waitcnt vmcnt(15)
v_xor_b32 v56, s28, v56
v_xor_b32 v57, s28, v57
v_xor_b32 v58, s28, v58
v_xor_b32 v59, s28, v59
buffer_store_dwordx4 v[56:59], v3, s[12:15], s24 offen
s_add_u32 s24, s24, 19456
s_waitcnt vmcnt(15)
v_xor_b32 v60, s28, v60
v_xor_b32 v61, s28, v61
v_xor_b32 v62, s28, v62
v_xor_b32 v63, s28, v63
buffer_store_dwordx4 v[60:63], v3, s[12:15], s24 offen
s_add_u32 s24, s24, 19456
s_waitcnt vmcnt(15)
v_xor_b32 v64, s28, v64
v_xor_b32 v65, s28, v65
v_xor_b32 v66, s28, v66
v_xor_b32 v67, s28, v67
buffer_store_dwordx4 v[64:67], v3, s[12:15], s24 offen
s_add_u32 s24, s24, 19456
s_waitcnt vmcnt(15)
v_xor_b32 v68, s28, v68
v_xor_b32 v69, s28, v69
v_xor_b32 v70, s28, v70
v_xor_b32 v71, s28, v71
buffer_store_dwordx4 v[68:71], v3, s[12:15], s24 offen
s_add_u32 s24, s24, 19456
s_waitcnt vmcnt(15)
v_xor_b32 v72, s28, v72
v_xor_b32 v73, s28, v73
v_xor_b32 v74, s28, v74
v_xor_b32 v75, s28, v75
buffer_store_dwordx4 v[72:75], v3, s[12:15], s24 offen
s_add_u32 s24, s24, 19456
s_waitcnt vmcnt(15)
v_xor_b32 v76, s28, v76
v_xor_b32 v77, s28, v77
v_xor_b32 v78, s28, v78
v_xor_b32 v79, s28, v79
buffer_store_dwordx4 v[76:79], v3, s[12:15], s24 offen
s_add_u32 s24, s24, 19456
L_prep_done:
s_endpgm
.p2align 8
.globl stage1_kernel
.type stage1_kernel,@function
stage1_kernel:
s_cmp_ge_u32 s2, 256
s_cbranch_scc1 L_s1_done
s_load_dwordx2 s[4:5], s[0:1], 88
s_load_dwordx2 s[6:7], s[0:1], 8
s_load_dwordx2 s[32:33], s[0:1], 16
s_load_dwordx2 s[56:57], s[0:1], 48
s_load_dwordx2 s[58:59], s[0:1], 56
v_and_b32 v1, 63, v0
v_lshrrev_b32 v2, 6, v0
s_nop 0
v_readfirstlane_b32 s3, v2
s_nop 3
s_sub_u32 s48, s2, 128
s_lshr_b32 s48, s48, 3
s_cmp_lt_u32 s48, 12
s_cselect_b32 s48, 3, 2
s_waitcnt lgkmcnt(0)
s_cmp_ge_u32 s3, 4
s_cbranch_scc1 L_s1_loader
s_lshr_b32 s34, s3, 1
s_and_b32 s35, s3, 1
s_lshl_b32 s36, s34, 6
s_lshl_b32 s37, s35, 6
s_add_u32 s38, s4, 5242880
s_addc_u32 s39, s5, 0
s_mov_b32 s16, s38
s_and_b32 s17, s39, 0xffff
s_mov_b32 s18, 9961472
s_mov_b32 s19, 0x00020000
v_and_b32 v2, 31, v1
v_lshrrev_b32 v3, 5, v1
v_lshrrev_b32 v4, 1, v2
v_and_b32 v4, 7, v4
v_xor_b32 v4, v4, v3
v_lshlrev_b32 v4, 4, v4
v_lshlrev_b32 v5, 7, v2
v_add_u32 v4, v4, v5
s_lshl_b32 s30, s37, 7
v_xor_b32 v5, 0, v4
v_add_u32 v24, s30, v5
v_add_u32 v28, 0x10000, v24
v_xor_b32 v5, 32, v4
v_add_u32 v25, s30, v5
v_add_u32 v29, 0x10000, v25
v_xor_b32 v5, 64, v4
v_add_u32 v26, s30, v5
v_add_u32 v30, 0x10000, v26
v_xor_b32 v5, 96, v4
v_add_u32 v27, s30, v5
v_add_u32 v31, 0x10000, v27
s_lshl_b32 s49, s3, 13
s_add_u32 s49, s49, 131072
s_cmp_ge_u32 s2, 128
s_cbranch_scc1 L_s1c_small
v_and_b32 v2, 15, v1
v_lshrrev_b32 v2, 2, v2
v_lshrrev_b32 v3, 5, v1
v_lshlrev_b32 v3, 3, v3
v_add_u32 v3, v3, v2
v_lshlrev_b32 v3, 8, v3
v_lshrrev_b32 v4, 4, v1
v_and_b32 v4, 1, v4
v_lshlrev_b32 v4, 1, v4
v_and_b32 v5, 3, v1
v_lshrrev_b32 v5, 1, v5
v_add_u32 v4, v4, v5
s_lshl_b32 s30, s34, 3
v_add_u32 v4, s30, v4
v_lshlrev_b32 v5, 2, v2
v_xor_b32 v4, v4, v5
v_lshlrev_b32 v4, 4, v4
v_add_u32 v3, v3, v4
v_and_b32 v4, 1, v1
v_lshlrev_b32 v4, 3, v4
v_add_u32 v16, v3, v4
v_xor_b32 v17, 64, v16
v_add_u32 v18, 0x10000, v16
v_add_u32 v19, 0x10000, v17
v_mov_b32 v96, 0
v_mov_b32 v97, 0
v_mov_b32 v98, 0
v_mov_b32 v99, 0
v_mov_b32 v100, 0
v_mov_b32 v101, 0
v_mov_b32 v102, 0
v_mov_b32 v103, 0
v_mov_b32 v104, 0
v_mov_b32 v105, 0
v_mov_b32 v106, 0
v_mov_b32 v107, 0
v_mov_b32 v108, 0
v_mov_b32 v109, 0
v_mov_b32 v110, 0
v_mov_b32 v111, 0
v_mov_b32 v112, 0
v_mov_b32 v113, 0
v_mov_b32 v114, 0
v_mov_b32 v115, 0
v_mov_b32 v116, 0
v_mov_b32 v117, 0
v_mov_b32 v118, 0
v_mov_b32 v119, 0
v_mov_b32 v120, 0
v_mov_b32 v121, 0
v_mov_b32 v122, 0
v_mov_b32 v123, 0
v_mov_b32 v124, 0
v_mov_b32 v125, 0
v_mov_b32 v126, 0
v_mov_b32 v127, 0
v_mov_b32 v128, 0
v_mov_b32 v129, 0
v_mov_b32 v130, 0
v_mov_b32 v131, 0
v_mov_b32 v132, 0
v_mov_b32 v133, 0
v_mov_b32 v134, 0
v_mov_b32 v135, 0
v_mov_b32 v136, 0
v_mov_b32 v137, 0
v_mov_b32 v138, 0
v_mov_b32 v139, 0
v_mov_b32 v140, 0
v_mov_b32 v141, 0
v_mov_b32 v142, 0
v_mov_b32 v143, 0
v_mov_b32 v144, 0
v_mov_b32 v145, 0
v_mov_b32 v146, 0
v_mov_b32 v147, 0
v_mov_b32 v148, 0
v_mov_b32 v149, 0
v_mov_b32 v150, 0
v_mov_b32 v151, 0
v_mov_b32 v152, 0
v_mov_b32 v153, 0
v_mov_b32 v154, 0
v_mov_b32 v155, 0
v_mov_b32 v156, 0
v_mov_b32 v157, 0
v_mov_b32 v158, 0
v_mov_b32 v159, 0
s_barrier
ds_read_b64_tr_b16 v[32:33], v16 offset:0
ds_read_b64_tr_b16 v[34:35], v16 offset:1024
ds_read_b64_tr_b16 v[36:37], v17 offset:0
ds_read_b64_tr_b16 v[38:39], v17 offset:1024
ds_read_b128 v[40:43], v24 offset:16384
ds_read_b128 v[44:47], v24 offset:20480
ds_read_b64_tr_b16 v[48:49], v16 offset:4096
ds_read_b64_tr_b16 v[50:51], v16 offset:5120
ds_read_b64_tr_b16 v[52:53], v17 offset:4096
ds_read_b64_tr_b16 v[54:55], v17 offset:5120
ds_read_b128 v[56:59], v25 offset:16384
ds_read_b128 v[60:63], v25 offset:20480
s_mov_b32 s27, 7
L_s1c_big_loop:
ds_read_b64_tr_b16 v[64:65], v16 offset:8192
ds_read_b64_tr_b16 v[66:67], v16 offset:9216
ds_read_b64_tr_b16 v[68:69], v17 offset:8192
ds_read_b64_tr_b16 v[70:71], v17 offset:9216
ds_read_b128 v[72:75], v26 offset:16384
ds_read_b128 v[76:79], v26 offset:20480
s_waitcnt lgkmcnt(12)
v_mfma_f32_32x32x16_bf16 v[96:111], v[32:35], v[40:43], v[96:111]
v_mfma_f32_32x32x16_bf16 v[112:127], v[32:35], v[44:47], v[112:127]
v_mfma_f32_32x32x16_bf16 v[128:143], v[36:39], v[40:43], v[128:143]
v_mfma_f32_32x32x16_bf16 v[144:159], v[36:39], v[44:47], v[144:159]
ds_read_b64_tr_b16 v[80:81], v16 offset:12288
ds_read_b64_tr_b16 v[82:83], v16 offset:13312
ds_read_b64_tr_b16 v[84:85], v17 offset:12288
ds_read_b64_tr_b16 v[86:87], v17 offset:13312
ds_read_b128 v[88:91], v27 offset:16384
ds_read_b128 v[92:95], v27 offset:20480
s_waitcnt lgkmcnt(12)
v_mfma_f32_32x32x16_bf16 v[96:111], v[48:51], v[56:59], v[96:111]
v_mfma_f32_32x32x16_bf16 v[112:127], v[48:51], v[60:63], v[112:127]
v_mfma_f32_32x32x16_bf16 v[128:143], v[52:55], v[56:59], v[128:143]
v_mfma_f32_32x32x16_bf16 v[144:159], v[52:55], v[60:63], v[144:159]
s_waitcnt lgkmcnt(0)
s_barrier
ds_read_b64_tr_b16 v[32:33], v16 offset:32768
ds_read_b64_tr_b16 v[34:35], v16 offset:33792
ds_read_b64_tr_b16 v[36:37], v17 offset:32768
ds_read_b64_tr_b16 v[38:39], v17 offset:33792
ds_read_b128 v[40:43], v24 offset:49152
ds_read_b128 v[44:47], v24 offset:53248
v_mfma_f32_32x32x16_bf16 v[96:111], v[64:67], v[72:75], v[96:111]
v_mfma_f32_32x32x16_bf16 v[112:127], v[64:67], v[76:79], v[112:127]
v_mfma_f32_32x32x16_bf16 v[128:143], v[68:71], v[72:75], v[128:143]
v_mfma_f32_32x32x16_bf16 v[144:159], v[68:71], v[76:79], v[144:159]
ds_read_b64_tr_b16 v[48:49], v16 offset:36864
ds_read_b64_tr_b16 v[50:51], v16 offset:37888
ds_read_b64_tr_b16 v[52:53], v17 offset:36864
ds_read_b64_tr_b16 v[54:55], v17 offset:37888
ds_read_b128 v[56:59], v25 offset:49152
ds_read_b128 v[60:63], v25 offset:53248
v_mfma_f32_32x32x16_bf16 v[96:111], v[80:83], v[88:91], v[96:111]
v_mfma_f32_32x32x16_bf16 v[112:127], v[80:83], v[92:95], v[112:127]
v_mfma_f32_32x32x16_bf16 v[128:143], v[84:87], v[88:91], v[128:143]
v_mfma_f32_32x32x16_bf16 v[144:159], v[84:87], v[92:95], v[144:159]
ds_read_b64_tr_b16 v[64:65], v16 offset:40960
ds_read_b64_tr_b16 v[66:67], v16 offset:41984
ds_read_b64_tr_b16 v[68:69], v17 offset:40960
ds_read_b64_tr_b16 v[70:71], v17 offset:41984
ds_read_b128 v[72:75], v26 offset:49152
ds_read_b128 v[76:79], v26 offset:53248
s_waitcnt lgkmcnt(12)
v_mfma_f32_32x32x16_bf16 v[96:111], v[32:35], v[40:43], v[96:111]
v_mfma_f32_32x32x16_bf16 v[112:127], v[32:35], v[44:47], v[112:127]
v_mfma_f32_32x32x16_bf16 v[128:143], v[36:39], v[40:43], v[128:143]
v_mfma_f32_32x32x16_bf16 v[144:159], v[36:39], v[44:47], v[144:159]
ds_read_b64_tr_b16 v[80:81], v16 offset:45056
ds_read_b64_tr_b16 v[82:83], v16 offset:46080
ds_read_b64_tr_b16 v[84:85], v17 offset:45056
ds_read_b64_tr_b16 v[86:87], v17 offset:46080
ds_read_b128 v[88:91], v27 offset:49152
ds_read_b128 v[92:95], v27 offset:53248
s_waitcnt lgkmcnt(12)
v_mfma_f32_32x32x16_bf16 v[96:111], v[48:51], v[56:59], v[96:111]
v_mfma_f32_32x32x16_bf16 v[112:127], v[48:51], v[60:63], v[112:127]
v_mfma_f32_32x32x16_bf16 v[128:143], v[52:55], v[56:59], v[128:143]
v_mfma_f32_32x32x16_bf16 v[144:159], v[52:55], v[60:63], v[144:159]
s_waitcnt lgkmcnt(0)
s_barrier
ds_read_b64_tr_b16 v[32:33], v18 offset:0
ds_read_b64_tr_b16 v[34:35], v18 offset:1024
ds_read_b64_tr_b16 v[36:37], v19 offset:0
ds_read_b64_tr_b16 v[38:39], v19 offset:1024
ds_read_b128 v[40:43], v28 offset:16384
ds_read_b128 v[44:47], v28 offset:20480
v_mfma_f32_32x32x16_bf16 v[96:111], v[64:67], v[72:75], v[96:111]
v_mfma_f32_32x32x16_bf16 v[112:127], v[64:67], v[76:79], v[112:127]
v_mfma_f32_32x32x16_bf16 v[128:143], v[68:71], v[72:75], v[128:143]
v_mfma_f32_32x32x16_bf16 v[144:159], v[68:71], v[76:79], v[144:159]
ds_read_b64_tr_b16 v[48:49], v18 offset:4096
ds_read_b64_tr_b16 v[50:51], v18 offset:5120
ds_read_b64_tr_b16 v[52:53], v19 offset:4096
ds_read_b64_tr_b16 v[54:55], v19 offset:5120
ds_read_b128 v[56:59], v29 offset:16384
ds_read_b128 v[60:63], v29 offset:20480
v_mfma_f32_32x32x16_bf16 v[96:111], v[80:83], v[88:91], v[96:111]
v_mfma_f32_32x32x16_bf16 v[112:127], v[80:83], v[92:95], v[112:127]
v_mfma_f32_32x32x16_bf16 v[128:143], v[84:87], v[88:91], v[128:143]
v_mfma_f32_32x32x16_bf16 v[144:159], v[84:87], v[92:95], v[144:159]
ds_read_b64_tr_b16 v[64:65], v18 offset:8192
ds_read_b64_tr_b16 v[66:67], v18 offset:9216
ds_read_b64_tr_b16 v[68:69], v19 offset:8192
ds_read_b64_tr_b16 v[70:71], v19 offset:9216
ds_read_b128 v[72:75], v30 offset:16384
ds_read_b128 v[76:79], v30 offset:20480
s_waitcnt lgkmcnt(12)
v_mfma_f32_32x32x16_bf16 v[96:111], v[32:35], v[40:43], v[96:111]
v_mfma_f32_32x32x16_bf16 v[112:127], v[32:35], v[44:47], v[112:127]
v_mfma_f32_32x32x16_bf16 v[128:143], v[36:39], v[40:43], v[128:143]
v_mfma_f32_32x32x16_bf16 v[144:159], v[36:39], v[44:47], v[144:159]
ds_read_b64_tr_b16 v[80:81], v18 offset:12288
ds_read_b64_tr_b16 v[82:83], v18 offset:13312
ds_read_b64_tr_b16 v[84:85], v19 offset:12288
ds_read_b64_tr_b16 v[86:87], v19 offset:13312
ds_read_b128 v[88:91], v31 offset:16384
ds_read_b128 v[92:95], v31 offset:20480
s_waitcnt lgkmcnt(12)
v_mfma_f32_32x32x16_bf16 v[96:111], v[48:51], v[56:59], v[96:111]
v_mfma_f32_32x32x16_bf16 v[112:127], v[48:51], v[60:63], v[112:127]
v_mfma_f32_32x32x16_bf16 v[128:143], v[52:55], v[56:59], v[128:143]
v_mfma_f32_32x32x16_bf16 v[144:159], v[52:55], v[60:63], v[144:159]
s_waitcnt lgkmcnt(0)
s_barrier
ds_read_b64_tr_b16 v[32:33], v18 offset:32768
ds_read_b64_tr_b16 v[34:35], v18 offset:33792
ds_read_b64_tr_b16 v[36:37], v19 offset:32768
ds_read_b64_tr_b16 v[38:39], v19 offset:33792
ds_read_b128 v[40:43], v28 offset:49152
ds_read_b128 v[44:47], v28 offset:53248
v_mfma_f32_32x32x16_bf16 v[96:111], v[64:67], v[72:75], v[96:111]
v_mfma_f32_32x32x16_bf16 v[112:127], v[64:67], v[76:79], v[112:127]
v_mfma_f32_32x32x16_bf16 v[128:143], v[68:71], v[72:75], v[128:143]
v_mfma_f32_32x32x16_bf16 v[144:159], v[68:71], v[76:79], v[144:159]
ds_read_b64_tr_b16 v[48:49], v18 offset:36864
ds_read_b64_tr_b16 v[50:51], v18 offset:37888
ds_read_b64_tr_b16 v[52:53], v19 offset:36864
ds_read_b64_tr_b16 v[54:55], v19 offset:37888
ds_read_b128 v[56:59], v29 offset:49152
ds_read_b128 v[60:63], v29 offset:53248
v_mfma_f32_32x32x16_bf16 v[96:111], v[80:83], v[88:91], v[96:111]
v_mfma_f32_32x32x16_bf16 v[112:127], v[80:83], v[92:95], v[112:127]
v_mfma_f32_32x32x16_bf16 v[128:143], v[84:87], v[88:91], v[128:143]
v_mfma_f32_32x32x16_bf16 v[144:159], v[84:87], v[92:95], v[144:159]
ds_read_b64_tr_b16 v[64:65], v18 offset:40960
ds_read_b64_tr_b16 v[66:67], v18 offset:41984
ds_read_b64_tr_b16 v[68:69], v19 offset:40960
ds_read_b64_tr_b16 v[70:71], v19 offset:41984
ds_read_b128 v[72:75], v30 offset:49152
ds_read_b128 v[76:79], v30 offset:53248
s_waitcnt lgkmcnt(12)
v_mfma_f32_32x32x16_bf16 v[96:111], v[32:35], v[40:43], v[96:111]
v_mfma_f32_32x32x16_bf16 v[112:127], v[32:35], v[44:47], v[112:127]
v_mfma_f32_32x32x16_bf16 v[128:143], v[36:39], v[40:43], v[128:143]
v_mfma_f32_32x32x16_bf16 v[144:159], v[36:39], v[44:47], v[144:159]
ds_read_b64_tr_b16 v[80:81], v18 offset:45056
ds_read_b64_tr_b16 v[82:83], v18 offset:46080
ds_read_b64_tr_b16 v[84:85], v19 offset:45056
ds_read_b64_tr_b16 v[86:87], v19 offset:46080
ds_read_b128 v[88:91], v31 offset:49152
ds_read_b128 v[92:95], v31 offset:53248
s_waitcnt lgkmcnt(12)
v_mfma_f32_32x32x16_bf16 v[96:111], v[48:51], v[56:59], v[96:111]
v_mfma_f32_32x32x16_bf16 v[112:127], v[48:51], v[60:63], v[112:127]
v_mfma_f32_32x32x16_bf16 v[128:143], v[52:55], v[56:59], v[128:143]
v_mfma_f32_32x32x16_bf16 v[144:159], v[52:55], v[60:63], v[144:159]
s_waitcnt lgkmcnt(0)
s_cmp_eq_u32 s27, 0
s_cbranch_scc1 L_s1cb_a
s_barrier
ds_read_b64_tr_b16 v[32:33], v16 offset:0
ds_read_b64_tr_b16 v[34:35], v16 offset:1024
ds_read_b64_tr_b16 v[36:37], v17 offset:0
ds_read_b64_tr_b16 v[38:39], v17 offset:1024
ds_read_b128 v[40:43], v24 offset:16384
ds_read_b128 v[44:47], v24 offset:20480
L_s1cb_a:
v_mfma_f32_32x32x16_bf16 v[96:111], v[64:67], v[72:75], v[96:111]
v_mfma_f32_32x32x16_bf16 v[112:127], v[64:67], v[76:79], v[112:127]
v_mfma_f32_32x32x16_bf16 v[128:143], v[68:71], v[72:75], v[128:143]
v_mfma_f32_32x32x16_bf16 v[144:159], v[68:71], v[76:79], v[144:159]
s_cmp_eq_u32 s27, 0
s_cbranch_scc1 L_s1cb_b5
ds_read_b64_tr_b16 v[48:49], v16 offset:4096
ds_read_b64_tr_b16 v[50:51], v16 offset:5120
ds_read_b64_tr_b16 v[52:53], v17 offset:4096
ds_read_b64_tr_b16 v[54:55], v17 offset:5120
ds_read_b128 v[56:59], v25 offset:16384
ds_read_b128 v[60:63], v25 offset:20480
L_s1cb_b5:
v_mfma_f32_32x32x16_bf16 v[96:111], v[80:83], v[88:91], v[96:111]
v_mfma_f32_32x32x16_bf16 v[112:127], v[80:83], v[92:95], v[112:127]
v_mfma_f32_32x32x16_bf16 v[128:143], v[84:87], v[88:91], v[128:143]
v_mfma_f32_32x32x16_bf16 v[144:159], v[84:87], v[92:95], v[144:159]
s_sub_u32 s27, s27, 1
s_cmp_ge_i32 s27, 0
s_cbranch_scc1 L_s1c_big_loop
s_nop 15
s_and_b32 s40, s2, 7
s_lshr_b32 s41, s2, 5
s_lshl_b32 s41, s41, 3
s_add_u32 s40, s40, s41
s_lshr_b32 s41, s2, 3
s_and_b32 s41, s41, 3
s_cmp_ge_u32 s40, 16
s_cselect_b32 s44, 512, 0
s_and_b32 s45, s40, 15
s_lshl_b32 s45, s45, 7
s_add_u32 s45, s45, s37
s_mul_i32 s45, s45, 4864
s_lshl_b32 s41, s41, 7
s_add_u32 s44, s44, s41
s_add_u32 s44, s44, s36
s_lshl_b32 s44, s44, 1
s_add_u32 s45, s45, s44
v_and_b32 v2, 31, v1
v_lshrrev_b32 v3, 1, v2
v_and_b32 v3, 7, v3
v_lshlrev_b32 v3, 4, v3
v_lshlrev_b32 v2, 7, v2
v_add_u32 v2, v2, v3
v_lshrrev_b32 v3, 5, v1
v_lshlrev_b32 v3, 3, v3
v_add_u32 v2, v2, v3
v_add_u32 v2, s49, v2
v_xor_b32 v4, 0, v2
v_cvt_pk_bf16_f32 v160, v96, v97
v_cvt_pk_bf16_f32 v161, v98, v99
ds_write_b64 v4, v[160:161] offset:0
v_cvt_pk_bf16_f32 v162, v112, v113
v_cvt_pk_bf16_f32 v163, v114, v115
ds_write_b64 v4, v[162:163] offset:4096
v_xor_b32 v4, 16, v2
v_cvt_pk_bf16_f32 v164, v100, v101
v_cvt_pk_bf16_f32 v165, v102, v103
ds_write_b64 v4, v[164:165] offset:0
v_cvt_pk_bf16_f32 v166, v116, v117
v_cvt_pk_bf16_f32 v167, v118, v119
ds_write_b64 v4, v[166:167] offset:4096
v_xor_b32 v4, 32, v2
v_cvt_pk_bf16_f32 v168, v104, v105
v_cvt_pk_bf16_f32 v169, v106, v107
ds_write_b64 v4, v[168:169] offset:0
v_cvt_pk_bf16_f32 v170, v120, v121
v_cvt_pk_bf16_f32 v171, v122, v123
ds_write_b64 v4, v[170:171] offset:4096
v_xor_b32 v4, 48, v2
v_cvt_pk_bf16_f32 v172, v108, v109
v_cvt_pk_bf16_f32 v173, v110, v111
ds_write_b64 v4, v[172:173] offset:0
v_cvt_pk_bf16_f32 v174, v124, v125
v_cvt_pk_bf16_f32 v175, v126, v127
ds_write_b64 v4, v[174:175] offset:4096
v_xor_b32 v4, 64, v2
v_cvt_pk_bf16_f32 v160, v128, v129
v_cvt_pk_bf16_f32 v161, v130, v131
ds_write_b64 v4, v[160:161] offset:0
v_cvt_pk_bf16_f32 v162, v144, v145
v_cvt_pk_bf16_f32 v163, v146, v147
ds_write_b64 v4, v[162:163] offset:4096
v_xor_b32 v4, 80, v2
v_cvt_pk_bf16_f32 v164, v132, v133
v_cvt_pk_bf16_f32 v165, v134, v135
ds_write_b64 v4, v[164:165] offset:0
v_cvt_pk_bf16_f32 v166, v148, v149
v_cvt_pk_bf16_f32 v167, v150, v151
ds_write_b64 v4, v[166:167] offset:4096
v_xor_b32 v4, 96, v2
v_cvt_pk_bf16_f32 v168, v136, v137
v_cvt_pk_bf16_f32 v169, v138, v139
ds_write_b64 v4, v[168:169] offset:0
v_cvt_pk_bf16_f32 v170, v152, v153
v_cvt_pk_bf16_f32 v171, v154, v155
ds_write_b64 v4, v[170:171] offset:4096
v_xor_b32 v4, 112, v2
v_cvt_pk_bf16_f32 v172, v140, v141
v_cvt_pk_bf16_f32 v173, v142, v143
ds_write_b64 v4, v[172:173] offset:0
v_cvt_pk_bf16_f32 v174, v156, v157
v_cvt_pk_bf16_f32 v175, v158, v159
ds_write_b64 v4, v[174:175] offset:4096
v_lshrrev_b32 v2, 3, v1
v_and_b32 v3, 7, v1
v_lshrrev_b32 v4, 4, v1
v_xor_b32 v4, v4, v3
v_lshlrev_b32 v4, 4, v4
v_lshlrev_b32 v5, 7, v2
v_add_u32 v4, v4, v5
v_add_u32 v4, s49, v4
v_xor_b32 v5, 64, v4
s_movk_i32 s29, 4864
v_mul_lo_u32 v6, v2, s29
v_lshlrev_b32 v3, 4, v3
v_add_u32 v6, v6, v3
s_waitcnt lgkmcnt(0)
ds_read_b128 v[160:163], v4 offset:0
ds_read_b128 v[164:167], v5 offset:1024
ds_read_b128 v[168:171], v4 offset:2048
ds_read_b128 v[172:175], v5 offset:3072
ds_read_b128 v[176:179], v4 offset:4096
ds_read_b128 v[180:183], v5 offset:5120
ds_read_b128 v[184:187], v4 offset:6144
ds_read_b128 v[188:191], v5 offset:7168
s_waitcnt lgkmcnt(7)
buffer_store_dwordx4 v[160:163], v6, s[16:19], s45 offen
s_add_u32 s45, s45, 38912
s_waitcnt lgkmcnt(6)
buffer_store_dwordx4 v[164:167], v6, s[16:19], s45 offen
s_add_u32 s45, s45, 38912
s_waitcnt lgkmcnt(5)
buffer_store_dwordx4 v[168:171], v6, s[16:19], s45 offen
s_add_u32 s45, s45, 38912
s_waitcnt lgkmcnt(4)
buffer_store_dwordx4 v[172:175], v6, s[16:19], s45 offen
s_add_u32 s45, s45, 38912
s_waitcnt lgkmcnt(3)
buffer_store_dwordx4 v[176:179], v6, s[16:19], s45 offen
s_add_u32 s45, s45, 38912
s_waitcnt lgkmcnt(2)
buffer_store_dwordx4 v[180:183], v6, s[16:19], s45 offen
s_add_u32 s45, s45, 38912
s_waitcnt lgkmcnt(1)
buffer_store_dwordx4 v[184:187], v6, s[16:19], s45 offen
s_add_u32 s45, s45, 38912
s_waitcnt lgkmcnt(0)
buffer_store_dwordx4 v[188:191], v6, s[16:19], s45 offen
s_add_u32 s45, s45, 38912
s_endpgm
L_s1c_small:
v_and_b32 v2, 15, v1
v_lshrrev_b32 v2, 2, v2
v_lshrrev_b32 v3, 5, v1
v_lshlrev_b32 v3, 3, v3
v_add_u32 v3, v3, v2
v_lshlrev_b32 v3, 7, v3
v_lshrrev_b32 v4, 4, v1
v_and_b32 v4, 1, v4
v_lshlrev_b32 v4, 1, v4
v_and_b32 v5, 3, v1
v_lshrrev_b32 v5, 1, v5
v_add_u32 v4, v4, v5
s_lshl_b32 s30, s34, 2
v_add_u32 v4, s30, v4
v_lshrrev_b32 v5, 3, v1
v_and_b32 v5, 1, v5
v_lshlrev_b32 v5, 2, v5
v_xor_b32 v4, v4, v5
v_lshlrev_b32 v4, 4, v4
v_add_u32 v3, v3, v4
v_and_b32 v4, 1, v1
v_lshlrev_b32 v4, 3, v4
v_add_u32 v16, v3, v4
v_add_u32 v17, 0x10000, v16
s_mov_b32 s46, 0xbdd2d3e8
s_mov_b32 s47, 0xbdd2d3e8
v_mov_b32 v14, 0xc0135761
v_mov_b32 v15, 0xc0135761
s_mov_b32 s54, 1.0
s_mov_b32 s55, 1.0
s_mov_b32 s50, 0
s_lshl_b32 s27, s48, 1
s_sub_u32 s27, s27, 1
v_and_b32 v2, 31, v1
v_lshrrev_b32 v3, 2, v2
v_and_b32 v3, 3, v3
v_lshlrev_b32 v3, 4, v3
v_lshlrev_b32 v2, 6, v2
v_add_u32 v2, v2, v3
v_lshrrev_b32 v3, 5, v1
v_lshlrev_b32 v3, 3, v3
v_add_u32 v2, v2, v3
v_add_u32 v7, s49, v2
v_lshrrev_b32 v2, 2, v1
v_and_b32 v3, 3, v1
v_lshrrev_b32 v4, 4, v1
v_and_b32 v4, 3, v4
v_xor_b32 v4, v4, v3
v_lshlrev_b32 v4, 4, v4
v_lshlrev_b32 v5, 6, v2
v_add_u32 v4, v4, v5
v_add_u32 v8, s49, v4
s_movk_i32 s29, 4864
v_mul_lo_u32 v9, v2, s29
v_lshlrev_b32 v3, 4, v3
v_add_u32 v9, v9, v3
s_barrier
ds_read_b64_tr_b16 v[32:33], v16 offset:0
ds_read_b64_tr_b16 v[34:35], v16 offset:512
ds_read_b64_tr_b16 v[36:37], v16 offset:8192
ds_read_b64_tr_b16 v[38:39], v16 offset:8704
ds_read_b128 v[40:43], v24 offset:16384
ds_read_b128 v[44:47], v24 offset:20480
ds_read_b64_tr_b16 v[48:49], v16 offset:2048
ds_read_b64_tr_b16 v[50:51], v16 offset:2560
ds_read_b64_tr_b16 v[52:53], v16 offset:10240
ds_read_b64_tr_b16 v[54:55], v16 offset:10752
ds_read_b128 v[56:59], v25 offset:16384
ds_read_b128 v[60:63], v25 offset:20480
L_s1c_tile:
v_mov_b32 v96, 0
v_mov_b32 v97, 0
v_mov_b32 v98, 0
v_mov_b32 v99, 0
v_mov_b32 v100, 0
v_mov_b32 v101, 0
v_mov_b32 v102, 0
v_mov_b32 v103, 0
v_mov_b32 v104, 0
v_mov_b32 v105, 0
v_mov_b32 v106, 0
v_mov_b32 v107, 0
v_mov_b32 v108, 0
v_mov_b32 v109, 0
v_mov_b32 v110, 0
v_mov_b32 v111, 0
v_mov_b32 v112, 0
v_mov_b32 v113, 0
v_mov_b32 v114, 0
v_mov_b32 v115, 0
v_mov_b32 v116, 0
v_mov_b32 v117, 0
v_mov_b32 v118, 0
v_mov_b32 v119, 0
v_mov_b32 v120, 0
v_mov_b32 v121, 0
v_mov_b32 v122, 0
v_mov_b32 v123, 0
v_mov_b32 v124, 0
v_mov_b32 v125, 0
v_mov_b32 v126, 0
v_mov_b32 v127, 0
v_mov_b32 v128, 0
v_mov_b32 v129, 0
v_mov_b32 v130, 0
v_mov_b32 v131, 0
v_mov_b32 v132, 0
v_mov_b32 v133, 0
v_mov_b32 v134, 0
v_mov_b32 v135, 0
v_mov_b32 v136, 0
v_mov_b32 v137, 0
v_mov_b32 v138, 0
v_mov_b32 v139, 0
v_mov_b32 v140, 0
v_mov_b32 v141, 0
v_mov_b32 v142, 0
v_mov_b32 v143, 0
v_mov_b32 v144, 0
v_mov_b32 v145, 0
v_mov_b32 v146, 0
v_mov_b32 v147, 0
v_mov_b32 v148, 0
v_mov_b32 v149, 0
v_mov_b32 v150, 0
v_mov_b32 v151, 0
v_mov_b32 v152, 0
v_mov_b32 v153, 0
v_mov_b32 v154, 0
v_mov_b32 v155, 0
v_mov_b32 v156, 0
v_mov_b32 v157, 0
v_mov_b32 v158, 0
v_mov_b32 v159, 0
ds_read_b64_tr_b16 v[64:65], v16 offset:4096
ds_read_b64_tr_b16 v[66:67], v16 offset:4608
ds_read_b64_tr_b16 v[68:69], v16 offset:12288
ds_read_b64_tr_b16 v[70:71], v16 offset:12800
ds_read_b128 v[72:75], v26 offset:16384
ds_read_b128 v[76:79], v26 offset:20480
s_waitcnt lgkmcnt(12)
v_mfma_f32_32x32x16_bf16 v[96:111], v[32:35], v[40:43], v[96:111]
v_mfma_f32_32x32x16_bf16 v[112:127], v[32:35], v[44:47], v[112:127]
v_mfma_f32_32x32x16_bf16 v[128:143], v[36:39], v[40:43], v[128:143]
v_mfma_f32_32x32x16_bf16 v[144:159], v[36:39], v[44:47], v[144:159]
ds_read_b64_tr_b16 v[80:81], v16 offset:6144
ds_read_b64_tr_b16 v[82:83], v16 offset:6656
ds_read_b64_tr_b16 v[84:85], v16 offset:14336
ds_read_b64_tr_b16 v[86:87], v16 offset:14848
ds_read_b128 v[88:91], v27 offset:16384
ds_read_b128 v[92:95], v27 offset:20480
s_waitcnt lgkmcnt(12)
v_mfma_f32_32x32x16_bf16 v[96:111], v[48:51], v[56:59], v[96:111]
v_mfma_f32_32x32x16_bf16 v[112:127], v[48:51], v[60:63], v[112:127]
v_mfma_f32_32x32x16_bf16 v[128:143], v[52:55], v[56:59], v[128:143]
v_mfma_f32_32x32x16_bf16 v[144:159], v[52:55], v[60:63], v[144:159]
s_waitcnt lgkmcnt(0)
s_barrier
ds_read_b64_tr_b16 v[32:33], v16 offset:32768
ds_read_b64_tr_b16 v[34:35], v16 offset:33280
ds_read_b64_tr_b16 v[36:37], v16 offset:40960
ds_read_b64_tr_b16 v[38:39], v16 offset:41472
ds_read_b128 v[40:43], v24 offset:49152
ds_read_b128 v[44:47], v24 offset:53248
v_mfma_f32_32x32x16_bf16 v[96:111], v[64:67], v[72:75], v[96:111]
v_mfma_f32_32x32x16_bf16 v[112:127], v[64:67], v[76:79], v[112:127]
v_mfma_f32_32x32x16_bf16 v[128:143], v[68:71], v[72:75], v[128:143]
v_mfma_f32_32x32x16_bf16 v[144:159], v[68:71], v[76:79], v[144:159]
ds_read_b64_tr_b16 v[48:49], v16 offset:34816
ds_read_b64_tr_b16 v[50:51], v16 offset:35328
ds_read_b64_tr_b16 v[52:53], v16 offset:43008
ds_read_b64_tr_b16 v[54:55], v16 offset:43520
ds_read_b128 v[56:59], v25 offset:49152
ds_read_b128 v[60:63], v25 offset:53248
v_mfma_f32_32x32x16_bf16 v[96:111], v[80:83], v[88:91], v[96:111]
v_mfma_f32_32x32x16_bf16 v[112:127], v[80:83], v[92:95], v[112:127]
v_mfma_f32_32x32x16_bf16 v[128:143], v[84:87], v[88:91], v[128:143]
v_mfma_f32_32x32x16_bf16 v[144:159], v[84:87], v[92:95], v[144:159]
ds_read_b64_tr_b16 v[64:65], v16 offset:36864
ds_read_b64_tr_b16 v[66:67], v16 offset:37376
ds_read_b64_tr_b16 v[68:69], v16 offset:45056
ds_read_b64_tr_b16 v[70:71], v16 offset:45568
ds_read_b128 v[72:75], v26 offset:49152
ds_read_b128 v[76:79], v26 offset:53248
s_waitcnt lgkmcnt(12)
v_mfma_f32_32x32x16_bf16 v[96:111], v[32:35], v[40:43], v[96:111]
v_mfma_f32_32x32x16_bf16 v[112:127], v[32:35], v[44:47], v[112:127]
v_mfma_f32_32x32x16_bf16 v[128:143], v[36:39], v[40:43], v[128:143]
v_mfma_f32_32x32x16_bf16 v[144:159], v[36:39], v[44:47], v[144:159]
ds_read_b64_tr_b16 v[80:81], v16 offset:38912
ds_read_b64_tr_b16 v[82:83], v16 offset:39424
ds_read_b64_tr_b16 v[84:85], v16 offset:47104
ds_read_b64_tr_b16 v[86:87], v16 offset:47616
ds_read_b128 v[88:91], v27 offset:49152
ds_read_b128 v[92:95], v27 offset:53248
s_waitcnt lgkmcnt(12)
v_mfma_f32_32x32x16_bf16 v[96:111], v[48:51], v[56:59], v[96:111]
v_mfma_f32_32x32x16_bf16 v[112:127], v[48:51], v[60:63], v[112:127]
v_mfma_f32_32x32x16_bf16 v[128:143], v[52:55], v[56:59], v[128:143]
v_mfma_f32_32x32x16_bf16 v[144:159], v[52:55], v[60:63], v[144:159]
s_waitcnt lgkmcnt(0)
s_barrier
ds_read_b64_tr_b16 v[32:33], v17 offset:0
ds_read_b64_tr_b16 v[34:35], v17 offset:512
ds_read_b64_tr_b16 v[36:37], v17 offset:8192
ds_read_b64_tr_b16 v[38:39], v17 offset:8704
ds_read_b128 v[40:43], v28 offset:16384
ds_read_b128 v[44:47], v28 offset:20480
v_mfma_f32_32x32x16_bf16 v[96:111], v[64:67], v[72:75], v[96:111]
v_mfma_f32_32x32x16_bf16 v[112:127], v[64:67], v[76:79], v[112:127]
v_mfma_f32_32x32x16_bf16 v[128:143], v[68:71], v[72:75], v[128:143]
v_mfma_f32_32x32x16_bf16 v[144:159], v[68:71], v[76:79], v[144:159]
ds_read_b64_tr_b16 v[48:49], v17 offset:2048
ds_read_b64_tr_b16 v[50:51], v17 offset:2560
ds_read_b64_tr_b16 v[52:53], v17 offset:10240
ds_read_b64_tr_b16 v[54:55], v17 offset:10752
ds_read_b128 v[56:59], v29 offset:16384
ds_read_b128 v[60:63], v29 offset:20480
v_mfma_f32_32x32x16_bf16 v[96:111], v[80:83], v[88:91], v[96:111]
v_mfma_f32_32x32x16_bf16 v[112:127], v[80:83], v[92:95], v[112:127]
v_mfma_f32_32x32x16_bf16 v[128:143], v[84:87], v[88:91], v[128:143]
v_mfma_f32_32x32x16_bf16 v[144:159], v[84:87], v[92:95], v[144:159]
ds_read_b64_tr_b16 v[64:65], v17 offset:4096
ds_read_b64_tr_b16 v[66:67], v17 offset:4608
ds_read_b64_tr_b16 v[68:69], v17 offset:12288
ds_read_b64_tr_b16 v[70:71], v17 offset:12800
ds_read_b128 v[72:75], v30 offset:16384
ds_read_b128 v[76:79], v30 offset:20480
s_waitcnt lgkmcnt(12)
v_mfma_f32_32x32x16_bf16 v[96:111], v[32:35], v[40:43], v[96:111]
v_mfma_f32_32x32x16_bf16 v[112:127], v[32:35], v[44:47], v[112:127]
v_mfma_f32_32x32x16_bf16 v[128:143], v[36:39], v[40:43], v[128:143]
v_mfma_f32_32x32x16_bf16 v[144:159], v[36:39], v[44:47], v[144:159]
ds_read_b64_tr_b16 v[80:81], v17 offset:6144
ds_read_b64_tr_b16 v[82:83], v17 offset:6656
ds_read_b64_tr_b16 v[84:85], v17 offset:14336
ds_read_b64_tr_b16 v[86:87], v17 offset:14848
ds_read_b128 v[88:91], v31 offset:16384
ds_read_b128 v[92:95], v31 offset:20480
s_waitcnt lgkmcnt(12)
v_mfma_f32_32x32x16_bf16 v[96:111], v[48:51], v[56:59], v[96:111]
v_mfma_f32_32x32x16_bf16 v[112:127], v[48:51], v[60:63], v[112:127]
v_mfma_f32_32x32x16_bf16 v[128:143], v[52:55], v[56:59], v[128:143]
v_mfma_f32_32x32x16_bf16 v[144:159], v[52:55], v[60:63], v[144:159]
s_waitcnt lgkmcnt(0)
s_barrier
ds_read_b64_tr_b16 v[32:33], v17 offset:32768
ds_read_b64_tr_b16 v[34:35], v17 offset:33280
ds_read_b64_tr_b16 v[36:37], v17 offset:40960
ds_read_b64_tr_b16 v[38:39], v17 offset:41472
ds_read_b128 v[40:43], v28 offset:49152
ds_read_b128 v[44:47], v28 offset:53248
v_mfma_f32_32x32x16_bf16 v[96:111], v[64:67], v[72:75], v[96:111]
v_mfma_f32_32x32x16_bf16 v[112:127], v[64:67], v[76:79], v[112:127]
v_mfma_f32_32x32x16_bf16 v[128:143], v[68:71], v[72:75], v[128:143]
v_mfma_f32_32x32x16_bf16 v[144:159], v[68:71], v[76:79], v[144:159]
ds_read_b64_tr_b16 v[48:49], v17 offset:34816
ds_read_b64_tr_b16 v[50:51], v17 offset:35328
ds_read_b64_tr_b16 v[52:53], v17 offset:43008
ds_read_b64_tr_b16 v[54:55], v17 offset:43520
ds_read_b128 v[56:59], v29 offset:49152
ds_read_b128 v[60:63], v29 offset:53248
v_mfma_f32_32x32x16_bf16 v[96:111], v[80:83], v[88:91], v[96:111]
v_mfma_f32_32x32x16_bf16 v[112:127], v[80:83], v[92:95], v[112:127]
v_mfma_f32_32x32x16_bf16 v[128:143], v[84:87], v[88:91], v[128:143]
v_mfma_f32_32x32x16_bf16 v[144:159], v[84:87], v[92:95], v[144:159]
ds_read_b64_tr_b16 v[64:65], v17 offset:36864
ds_read_b64_tr_b16 v[66:67], v17 offset:37376
ds_read_b64_tr_b16 v[68:69], v17 offset:45056
ds_read_b64_tr_b16 v[70:71], v17 offset:45568
ds_read_b128 v[72:75], v30 offset:49152
ds_read_b128 v[76:79], v30 offset:53248
s_waitcnt lgkmcnt(12)
v_mfma_f32_32x32x16_bf16 v[96:111], v[32:35], v[40:43], v[96:111]
v_mfma_f32_32x32x16_bf16 v[112:127], v[32:35], v[44:47], v[112:127]
v_mfma_f32_32x32x16_bf16 v[128:143], v[36:39], v[40:43], v[128:143]
v_mfma_f32_32x32x16_bf16 v[144:159], v[36:39], v[44:47], v[144:159]
ds_read_b64_tr_b16 v[80:81], v17 offset:38912
ds_read_b64_tr_b16 v[82:83], v17 offset:39424
ds_read_b64_tr_b16 v[84:85], v17 offset:47104
ds_read_b64_tr_b16 v[86:87], v17 offset:47616
ds_read_b128 v[88:91], v31 offset:49152
ds_read_b128 v[92:95], v31 offset:53248
s_waitcnt lgkmcnt(12)
v_mfma_f32_32x32x16_bf16 v[96:111], v[48:51], v[56:59], v[96:111]
v_mfma_f32_32x32x16_bf16 v[112:127], v[48:51], v[60:63], v[112:127]
v_mfma_f32_32x32x16_bf16 v[128:143], v[52:55], v[56:59], v[128:143]
v_mfma_f32_32x32x16_bf16 v[144:159], v[52:55], v[60:63], v[144:159]
s_waitcnt lgkmcnt(0)
s_cmp_eq_u32 s27, 0
s_cbranch_scc1 L_s1cs0_a
s_barrier
ds_read_b64_tr_b16 v[32:33], v16 offset:0
ds_read_b64_tr_b16 v[34:35], v16 offset:512
ds_read_b64_tr_b16 v[36:37], v16 offset:8192
ds_read_b64_tr_b16 v[38:39], v16 offset:8704
ds_read_b128 v[40:43], v24 offset:16384
ds_read_b128 v[44:47], v24 offset:20480
L_s1cs0_a:
v_mfma_f32_32x32x16_bf16 v[96:111], v[64:67], v[72:75], v[96:111]
v_mfma_f32_32x32x16_bf16 v[112:127], v[64:67], v[76:79], v[112:127]
v_mfma_f32_32x32x16_bf16 v[128:143], v[68:71], v[72:75], v[128:143]
v_mfma_f32_32x32x16_bf16 v[144:159], v[68:71], v[76:79], v[144:159]
s_cmp_eq_u32 s27, 0
s_cbranch_scc1 L_s1cs0_b5
ds_read_b64_tr_b16 v[48:49], v16 offset:2048
ds_read_b64_tr_b16 v[50:51], v16 offset:2560
ds_read_b64_tr_b16 v[52:53], v16 offset:10240
ds_read_b64_tr_b16 v[54:55], v16 offset:10752
ds_read_b128 v[56:59], v25 offset:16384
ds_read_b128 v[60:63], v25 offset:20480
L_s1cs0_b5:
v_mfma_f32_32x32x16_bf16 v[96:111], v[80:83], v[88:91], v[96:111]
v_mfma_f32_32x32x16_bf16 v[112:127], v[80:83], v[92:95], v[112:127]
v_mfma_f32_32x32x16_bf16 v[128:143], v[84:87], v[88:91], v[128:143]
v_mfma_f32_32x32x16_bf16 v[144:159], v[84:87], v[92:95], v[144:159]
s_sub_u32 s27, s27, 1
ds_read_b64_tr_b16 v[64:65], v16 offset:4096
ds_read_b64_tr_b16 v[66:67], v16 offset:4608
ds_read_b64_tr_b16 v[68:69], v16 offset:12288
ds_read_b64_tr_b16 v[70:71], v16 offset:12800
ds_read_b128 v[72:75], v26 offset:16384
ds_read_b128 v[76:79], v26 offset:20480
s_waitcnt lgkmcnt(12)
v_mfma_f32_32x32x16_bf16 v[96:111], v[32:35], v[40:43], v[96:111]
v_mfma_f32_32x32x16_bf16 v[112:127], v[32:35], v[44:47], v[112:127]
v_mfma_f32_32x32x16_bf16 v[128:143], v[36:39], v[40:43], v[128:143]
v_mfma_f32_32x32x16_bf16 v[144:159], v[36:39], v[44:47], v[144:159]
ds_read_b64_tr_b16 v[80:81], v16 offset:6144
ds_read_b64_tr_b16 v[82:83], v16 offset:6656
ds_read_b64_tr_b16 v[84:85], v16 offset:14336
ds_read_b64_tr_b16 v[86:87], v16 offset:14848
ds_read_b128 v[88:91], v27 offset:16384
ds_read_b128 v[92:95], v27 offset:20480
s_waitcnt lgkmcnt(12)
v_mfma_f32_32x32x16_bf16 v[96:111], v[48:51], v[56:59], v[96:111]
v_mfma_f32_32x32x16_bf16 v[112:127], v[48:51], v[60:63], v[112:127]
v_mfma_f32_32x32x16_bf16 v[128:143], v[52:55], v[56:59], v[128:143]
v_mfma_f32_32x32x16_bf16 v[144:159], v[52:55], v[60:63], v[144:159]
s_waitcnt lgkmcnt(0)
s_barrier
ds_read_b64_tr_b16 v[32:33], v16 offset:32768
ds_read_b64_tr_b16 v[34:35], v16 offset:33280
ds_read_b64_tr_b16 v[36:37], v16 offset:40960
ds_read_b64_tr_b16 v[38:39], v16 offset:41472
ds_read_b128 v[40:43], v24 offset:49152
ds_read_b128 v[44:47], v24 offset:53248
v_mfma_f32_32x32x16_bf16 v[96:111], v[64:67], v[72:75], v[96:111]
v_mfma_f32_32x32x16_bf16 v[112:127], v[64:67], v[76:79], v[112:127]
v_mfma_f32_32x32x16_bf16 v[128:143], v[68:71], v[72:75], v[128:143]
v_mfma_f32_32x32x16_bf16 v[144:159], v[68:71], v[76:79], v[144:159]
ds_read_b64_tr_b16 v[48:49], v16 offset:34816
ds_read_b64_tr_b16 v[50:51], v16 offset:35328
ds_read_b64_tr_b16 v[52:53], v16 offset:43008
ds_read_b64_tr_b16 v[54:55], v16 offset:43520
ds_read_b128 v[56:59], v25 offset:49152
ds_read_b128 v[60:63], v25 offset:53248
v_mfma_f32_32x32x16_bf16 v[96:111], v[80:83], v[88:91], v[96:111]
v_mfma_f32_32x32x16_bf16 v[112:127], v[80:83], v[92:95], v[112:127]
v_mfma_f32_32x32x16_bf16 v[128:143], v[84:87], v[88:91], v[128:143]
v_mfma_f32_32x32x16_bf16 v[144:159], v[84:87], v[92:95], v[144:159]
ds_read_b64_tr_b16 v[64:65], v16 offset:36864
ds_read_b64_tr_b16 v[66:67], v16 offset:37376
ds_read_b64_tr_b16 v[68:69], v16 offset:45056
ds_read_b64_tr_b16 v[70:71], v16 offset:45568
ds_read_b128 v[72:75], v26 offset:49152
ds_read_b128 v[76:79], v26 offset:53248
s_waitcnt lgkmcnt(12)
v_mfma_f32_32x32x16_bf16 v[96:111], v[32:35], v[40:43], v[96:111]
v_mfma_f32_32x32x16_bf16 v[112:127], v[32:35], v[44:47], v[112:127]
v_mfma_f32_32x32x16_bf16 v[128:143], v[36:39], v[40:43], v[128:143]
v_mfma_f32_32x32x16_bf16 v[144:159], v[36:39], v[44:47], v[144:159]
ds_read_b64_tr_b16 v[80:81], v16 offset:38912
ds_read_b64_tr_b16 v[82:83], v16 offset:39424
ds_read_b64_tr_b16 v[84:85], v16 offset:47104
ds_read_b64_tr_b16 v[86:87], v16 offset:47616
ds_read_b128 v[88:91], v27 offset:49152
ds_read_b128 v[92:95], v27 offset:53248
s_waitcnt lgkmcnt(12)
v_mfma_f32_32x32x16_bf16 v[96:111], v[48:51], v[56:59], v[96:111]
v_mfma_f32_32x32x16_bf16 v[112:127], v[48:51], v[60:63], v[112:127]
v_mfma_f32_32x32x16_bf16 v[128:143], v[52:55], v[56:59], v[128:143]
v_mfma_f32_32x32x16_bf16 v[144:159], v[52:55], v[60:63], v[144:159]
s_waitcnt lgkmcnt(0)
s_barrier
ds_read_b64_tr_b16 v[32:33], v17 offset:0
ds_read_b64_tr_b16 v[34:35], v17 offset:512
ds_read_b64_tr_b16 v[36:37], v17 offset:8192
ds_read_b64_tr_b16 v[38:39], v17 offset:8704
ds_read_b128 v[40:43], v28 offset:16384
ds_read_b128 v[44:47], v28 offset:20480
v_mfma_f32_32x32x16_bf16 v[96:111], v[64:67], v[72:75], v[96:111]
v_mfma_f32_32x32x16_bf16 v[112:127], v[64:67], v[76:79], v[112:127]
v_mfma_f32_32x32x16_bf16 v[128:143], v[68:71], v[72:75], v[128:143]
v_mfma_f32_32x32x16_bf16 v[144:159], v[68:71], v[76:79], v[144:159]
ds_read_b64_tr_b16 v[48:49], v17 offset:2048
ds_read_b64_tr_b16 v[50:51], v17 offset:2560
ds_read_b64_tr_b16 v[52:53], v17 offset:10240
ds_read_b64_tr_b16 v[54:55], v17 offset:10752
ds_read_b128 v[56:59], v29 offset:16384
ds_read_b128 v[60:63], v29 offset:20480
v_mfma_f32_32x32x16_bf16 v[96:111], v[80:83], v[88:91], v[96:111]
v_mfma_f32_32x32x16_bf16 v[112:127], v[80:83], v[92:95], v[112:127]
v_mfma_f32_32x32x16_bf16 v[128:143], v[84:87], v[88:91], v[128:143]
v_mfma_f32_32x32x16_bf16 v[144:159], v[84:87], v[92:95], v[144:159]
ds_read_b64_tr_b16 v[64:65], v17 offset:4096
ds_read_b64_tr_b16 v[66:67], v17 offset:4608
ds_read_b64_tr_b16 v[68:69], v17 offset:12288
ds_read_b64_tr_b16 v[70:71], v17 offset:12800
ds_read_b128 v[72:75], v30 offset:16384
ds_read_b128 v[76:79], v30 offset:20480
s_waitcnt lgkmcnt(12)
v_mfma_f32_32x32x16_bf16 v[96:111], v[32:35], v[40:43], v[96:111]
v_mfma_f32_32x32x16_bf16 v[112:127], v[32:35], v[44:47], v[112:127]
v_mfma_f32_32x32x16_bf16 v[128:143], v[36:39], v[40:43], v[128:143]
v_mfma_f32_32x32x16_bf16 v[144:159], v[36:39], v[44:47], v[144:159]
ds_read_b64_tr_b16 v[80:81], v17 offset:6144
ds_read_b64_tr_b16 v[82:83], v17 offset:6656
ds_read_b64_tr_b16 v[84:85], v17 offset:14336
ds_read_b64_tr_b16 v[86:87], v17 offset:14848
ds_read_b128 v[88:91], v31 offset:16384
ds_read_b128 v[92:95], v31 offset:20480
s_waitcnt lgkmcnt(12)
v_mfma_f32_32x32x16_bf16 v[96:111], v[48:51], v[56:59], v[96:111]
v_mfma_f32_32x32x16_bf16 v[112:127], v[48:51], v[60:63], v[112:127]
v_mfma_f32_32x32x16_bf16 v[128:143], v[52:55], v[56:59], v[128:143]
v_mfma_f32_32x32x16_bf16 v[144:159], v[52:55], v[60:63], v[144:159]
s_waitcnt lgkmcnt(0)
s_barrier
ds_read_b64_tr_b16 v[32:33], v17 offset:32768
ds_read_b64_tr_b16 v[34:35], v17 offset:33280
ds_read_b64_tr_b16 v[36:37], v17 offset:40960
ds_read_b64_tr_b16 v[38:39], v17 offset:41472
ds_read_b128 v[40:43], v28 offset:49152
ds_read_b128 v[44:47], v28 offset:53248
v_mfma_f32_32x32x16_bf16 v[96:111], v[64:67], v[72:75], v[96:111]
v_mfma_f32_32x32x16_bf16 v[112:127], v[64:67], v[76:79], v[112:127]
v_mfma_f32_32x32x16_bf16 v[128:143], v[68:71], v[72:75], v[128:143]
v_mfma_f32_32x32x16_bf16 v[144:159], v[68:71], v[76:79], v[144:159]
ds_read_b64_tr_b16 v[48:49], v17 offset:34816
ds_read_b64_tr_b16 v[50:51], v17 offset:35328
ds_read_b64_tr_b16 v[52:53], v17 offset:43008
ds_read_b64_tr_b16 v[54:55], v17 offset:43520
ds_read_b128 v[56:59], v29 offset:49152
ds_read_b128 v[60:63], v29 offset:53248
v_mfma_f32_32x32x16_bf16 v[96:111], v[80:83], v[88:91], v[96:111]
v_mfma_f32_32x32x16_bf16 v[112:127], v[80:83], v[92:95], v[112:127]
v_mfma_f32_32x32x16_bf16 v[128:143], v[84:87], v[88:91], v[128:143]
v_mfma_f32_32x32x16_bf16 v[144:159], v[84:87], v[92:95], v[144:159]
ds_read_b64_tr_b16 v[64:65], v17 offset:36864
ds_read_b64_tr_b16 v[66:67], v17 offset:37376
ds_read_b64_tr_b16 v[68:69], v17 offset:45056
ds_read_b64_tr_b16 v[70:71], v17 offset:45568
ds_read_b128 v[72:75], v30 offset:49152
ds_read_b128 v[76:79], v30 offset:53248
s_waitcnt lgkmcnt(12)
v_mfma_f32_32x32x16_bf16 v[96:111], v[32:35], v[40:43], v[96:111]
v_mfma_f32_32x32x16_bf16 v[112:127], v[32:35], v[44:47], v[112:127]
v_mfma_f32_32x32x16_bf16 v[128:143], v[36:39], v[40:43], v[128:143]
v_mfma_f32_32x32x16_bf16 v[144:159], v[36:39], v[44:47], v[144:159]
ds_read_b64_tr_b16 v[80:81], v17 offset:38912
ds_read_b64_tr_b16 v[82:83], v17 offset:39424
ds_read_b64_tr_b16 v[84:85], v17 offset:47104
ds_read_b64_tr_b16 v[86:87], v17 offset:47616
ds_read_b128 v[88:91], v31 offset:49152
ds_read_b128 v[92:95], v31 offset:53248
s_waitcnt lgkmcnt(12)
v_mfma_f32_32x32x16_bf16 v[96:111], v[48:51], v[56:59], v[96:111]
v_mfma_f32_32x32x16_bf16 v[112:127], v[48:51], v[60:63], v[112:127]
v_mfma_f32_32x32x16_bf16 v[128:143], v[52:55], v[56:59], v[128:143]
v_mfma_f32_32x32x16_bf16 v[144:159], v[52:55], v[60:63], v[144:159]
s_waitcnt lgkmcnt(0)
s_cmp_eq_u32 s27, 0
s_cbranch_scc1 L_s1cs1_a
s_barrier
ds_read_b64_tr_b16 v[32:33], v16 offset:0
ds_read_b64_tr_b16 v[34:35], v16 offset:512
ds_read_b64_tr_b16 v[36:37], v16 offset:8192
ds_read_b64_tr_b16 v[38:39], v16 offset:8704
ds_read_b128 v[40:43], v24 offset:16384
ds_read_b128 v[44:47], v24 offset:20480
L_s1cs1_a:
v_mfma_f32_32x32x16_bf16 v[96:111], v[64:67], v[72:75], v[96:111]
v_mfma_f32_32x32x16_bf16 v[112:127], v[64:67], v[76:79], v[112:127]
v_mfma_f32_32x32x16_bf16 v[128:143], v[68:71], v[72:75], v[128:143]
v_mfma_f32_32x32x16_bf16 v[144:159], v[68:71], v[76:79], v[144:159]
s_cmp_eq_u32 s27, 0
s_cbranch_scc1 L_s1cs1_b5
ds_read_b64_tr_b16 v[48:49], v16 offset:2048
ds_read_b64_tr_b16 v[50:51], v16 offset:2560
ds_read_b64_tr_b16 v[52:53], v16 offset:10240
ds_read_b64_tr_b16 v[54:55], v16 offset:10752
ds_read_b128 v[56:59], v25 offset:16384
ds_read_b128 v[60:63], v25 offset:20480
L_s1cs1_b5:
v_mfma_f32_32x32x16_bf16 v[96:111], v[80:83], v[88:91], v[96:111]
v_mfma_f32_32x32x16_bf16 v[112:127], v[80:83], v[92:95], v[112:127]
v_mfma_f32_32x32x16_bf16 v[128:143], v[84:87], v[88:91], v[128:143]
v_mfma_f32_32x32x16_bf16 v[144:159], v[84:87], v[92:95], v[144:159]
s_sub_u32 s27, s27, 1
s_nop 15
s_sub_u32 s42, s2, 128
s_and_b32 s43, s42, 7
s_lshr_b32 s42, s42, 3
s_lshl_b32 s44, s50, 4
s_add_u32 s42, s42, s44
s_lshr_b32 s40, s42, 1
s_and_b32 s42, s42, 1
s_lshl_b32 s41, s43, 1
s_add_u32 s41, s41, s42
s_lshl_b32 s45, s41, 7
s_add_u32 s45, s45, s37
s_mul_i32 s45, s45, 4864
s_lshl_b32 s44, s40, 1
s_add_u32 s44, s44, s34
s_lshl_b32 s44, s44, 6
s_add_u32 s45, s45, s44
s_add_u32 s45, s45, 2048
v_pk_mul_f32 v[160:161], v[96:97], v[96:97]
v_pk_mul_f32 v[162:163], v[98:99], v[98:99]
v_pk_mul_f32 v[164:165], v[100:101], v[100:101]
v_pk_mul_f32 v[166:167], v[102:103], v[102:103]
v_pk_fma_f32 v[160:161], v[160:161], s[46:47], v[14:15]
v_pk_fma_f32 v[162:163], v[162:163], s[46:47], v[14:15]
v_pk_fma_f32 v[164:165], v[164:165], s[46:47], v[14:15]
v_pk_fma_f32 v[166:167], v[166:167], s[46:47], v[14:15]
v_pk_mul_f32 v[160:161], v[160:161], v[96:97]
v_pk_mul_f32 v[162:163], v[162:163], v[98:99]
v_pk_mul_f32 v[164:165], v[164:165], v[100:101]
v_pk_mul_f32 v[166:167], v[166:167], v[102:103]
v_exp_f32 v160, v160
v_exp_f32 v161, v161
v_exp_f32 v162, v162
v_exp_f32 v163, v163
v_exp_f32 v164, v164
v_exp_f32 v165, v165
v_exp_f32 v166, v166
v_exp_f32 v167, v167
v_pk_add_f32 v[160:161], v[160:161], s[54:55]
v_pk_add_f32 v[162:163], v[162:163], s[54:55]
v_pk_add_f32 v[164:165], v[164:165], s[54:55]
v_pk_add_f32 v[166:167], v[166:167], s[54:55]
v_rcp_f32 v160, v160
v_rcp_f32 v161, v161
v_rcp_f32 v162, v162
v_rcp_f32 v163, v163
v_rcp_f32 v164, v164
v_rcp_f32 v165, v165
v_rcp_f32 v166, v166
v_rcp_f32 v167, v167
v_pk_mul_f32 v[168:169], v[96:97], v[128:129]
v_pk_mul_f32 v[170:171], v[98:99], v[130:131]
v_pk_mul_f32 v[172:173], v[100:101], v[132:133]
v_pk_mul_f32 v[174:175], v[102:103], v[134:135]
v_pk_mul_f32 v[160:161], v[160:161], v[168:169]
v_pk_mul_f32 v[162:163], v[162:163], v[170:171]
v_pk_mul_f32 v[164:165], v[164:165], v[172:173]
v_pk_mul_f32 v[166:167], v[166:167], v[174:175]
v_cvt_pk_bf16_f32 v168, v160, v161
v_cvt_pk_bf16_f32 v169, v162, v163
v_xor_b32 v172, 0, v7
ds_write_b64 v172, v[168:169] offset:0
v_cvt_pk_bf16_f32 v170, v164, v165
v_cvt_pk_bf16_f32 v171, v166, v167
v_xor_b32 v173, 16, v7
ds_write_b64 v173, v[170:171] offset:0
v_pk_mul_f32 v[176:177], v[104:105], v[104:105]
v_pk_mul_f32 v[178:179], v[106:107], v[106:107]
v_pk_mul_f32 v[180:181], v[108:109], v[108:109]
v_pk_mul_f32 v[182:183], v[110:111], v[110:111]
v_pk_fma_f32 v[176:177], v[176:177], s[46:47], v[14:15]
v_pk_fma_f32 v[178:179], v[178:179], s[46:47], v[14:15]
v_pk_fma_f32 v[180:181], v[180:181], s[46:47], v[14:15]
v_pk_fma_f32 v[182:183], v[182:183], s[46:47], v[14:15]
v_pk_mul_f32 v[176:177], v[176:177], v[104:105]
v_pk_mul_f32 v[178:179], v[178:179], v[106:107]
v_pk_mul_f32 v[180:181], v[180:181], v[108:109]
v_pk_mul_f32 v[182:183], v[182:183], v[110:111]
v_exp_f32 v176, v176
v_exp_f32 v177, v177
v_exp_f32 v178, v178
v_exp_f32 v179, v179
v_exp_f32 v180, v180
v_exp_f32 v181, v181
v_exp_f32 v182, v182
v_exp_f32 v183, v183
v_pk_add_f32 v[176:177], v[176:177], s[54:55]
v_pk_add_f32 v[178:179], v[178:179], s[54:55]
v_pk_add_f32 v[180:181], v[180:181], s[54:55]
v_pk_add_f32 v[182:183], v[182:183], s[54:55]
v_rcp_f32 v176, v176
v_rcp_f32 v177, v177
v_rcp_f32 v178, v178
v_rcp_f32 v179, v179
v_rcp_f32 v180, v180
v_rcp_f32 v181, v181
v_rcp_f32 v182, v182
v_rcp_f32 v183, v183
v_pk_mul_f32 v[184:185], v[104:105], v[136:137]
v_pk_mul_f32 v[186:187], v[106:107], v[138:139]
v_pk_mul_f32 v[188:189], v[108:109], v[140:141]
v_pk_mul_f32 v[190:191], v[110:111], v[142:143]
v_pk_mul_f32 v[176:177], v[176:177], v[184:185]
v_pk_mul_f32 v[178:179], v[178:179], v[186:187]
v_pk_mul_f32 v[180:181], v[180:181], v[188:189]
v_pk_mul_f32 v[182:183], v[182:183], v[190:191]
v_cvt_pk_bf16_f32 v184, v176, v177
v_cvt_pk_bf16_f32 v185, v178, v179
v_xor_b32 v188, 32, v7
ds_write_b64 v188, v[184:185] offset:0
v_cvt_pk_bf16_f32 v186, v180, v181
v_cvt_pk_bf16_f32 v187, v182, v183
v_xor_b32 v189, 48, v7
ds_write_b64 v189, v[186:187] offset:0
v_pk_mul_f32 v[160:161], v[112:113], v[112:113]
v_pk_mul_f32 v[162:163], v[114:115], v[114:115]
v_pk_mul_f32 v[164:165], v[116:117], v[116:117]
v_pk_mul_f32 v[166:167], v[118:119], v[118:119]
v_pk_fma_f32 v[160:161], v[160:161], s[46:47], v[14:15]
v_pk_fma_f32 v[162:163], v[162:163], s[46:47], v[14:15]
v_pk_fma_f32 v[164:165], v[164:165], s[46:47], v[14:15]
v_pk_fma_f32 v[166:167], v[166:167], s[46:47], v[14:15]
v_pk_mul_f32 v[160:161], v[160:161], v[112:113]
v_pk_mul_f32 v[162:163], v[162:163], v[114:115]
v_pk_mul_f32 v[164:165], v[164:165], v[116:117]
v_pk_mul_f32 v[166:167], v[166:167], v[118:119]
v_exp_f32 v160, v160
v_exp_f32 v161, v161
v_exp_f32 v162, v162
v_exp_f32 v163, v163
v_exp_f32 v164, v164
v_exp_f32 v165, v165
v_exp_f32 v166, v166
v_exp_f32 v167, v167
v_pk_add_f32 v[160:161], v[160:161], s[54:55]
v_pk_add_f32 v[162:163], v[162:163], s[54:55]
v_pk_add_f32 v[164:165], v[164:165], s[54:55]
v_pk_add_f32 v[166:167], v[166:167], s[54:55]
v_rcp_f32 v160, v160
v_rcp_f32 v161, v161
v_rcp_f32 v162, v162
v_rcp_f32 v163, v163
v_rcp_f32 v164, v164
v_rcp_f32 v165, v165
v_rcp_f32 v166, v166
v_rcp_f32 v167, v167
v_pk_mul_f32 v[168:169], v[112:113], v[144:145]
v_pk_mul_f32 v[170:171], v[114:115], v[146:147]
v_pk_mul_f32 v[172:173], v[116:117], v[148:149]
v_pk_mul_f32 v[174:175], v[118:119], v[150:151]
v_pk_mul_f32 v[160:161], v[160:161], v[168:169]
v_pk_mul_f32 v[162:163], v[162:163], v[170:171]
v_pk_mul_f32 v[164:165], v[164:165], v[172:173]
v_pk_mul_f32 v[166:167], v[166:167], v[174:175]
v_cvt_pk_bf16_f32 v168, v160, v161
v_cvt_pk_bf16_f32 v169, v162, v163
v_xor_b32 v172, 0, v7
ds_write_b64 v172, v[168:169] offset:2048
v_cvt_pk_bf16_f32 v170, v164, v165
v_cvt_pk_bf16_f32 v171, v166, v167
v_xor_b32 v173, 16, v7
ds_write_b64 v173, v[170:171] offset:2048
v_pk_mul_f32 v[176:177], v[120:121], v[120:121]
v_pk_mul_f32 v[178:179], v[122:123], v[122:123]
v_pk_mul_f32 v[180:181], v[124:125], v[124:125]
v_pk_mul_f32 v[182:183], v[126:127], v[126:127]
v_pk_fma_f32 v[176:177], v[176:177], s[46:47], v[14:15]
v_pk_fma_f32 v[178:179], v[178:179], s[46:47], v[14:15]
v_pk_fma_f32 v[180:181], v[180:181], s[46:47], v[14:15]
v_pk_fma_f32 v[182:183], v[182:183], s[46:47], v[14:15]
v_pk_mul_f32 v[176:177], v[176:177], v[120:121]
v_pk_mul_f32 v[178:179], v[178:179], v[122:123]
v_pk_mul_f32 v[180:181], v[180:181], v[124:125]
v_pk_mul_f32 v[182:183], v[182:183], v[126:127]
v_exp_f32 v176, v176
v_exp_f32 v177, v177
v_exp_f32 v178, v178
v_exp_f32 v179, v179
v_exp_f32 v180, v180
v_exp_f32 v181, v181
v_exp_f32 v182, v182
v_exp_f32 v183, v183
v_pk_add_f32 v[176:177], v[176:177], s[54:55]
v_pk_add_f32 v[178:179], v[178:179], s[54:55]
v_pk_add_f32 v[180:181], v[180:181], s[54:55]
v_pk_add_f32 v[182:183], v[182:183], s[54:55]
v_rcp_f32 v176, v176
v_rcp_f32 v177, v177
v_rcp_f32 v178, v178
v_rcp_f32 v179, v179
v_rcp_f32 v180, v180
v_rcp_f32 v181, v181
v_rcp_f32 v182, v182
v_rcp_f32 v183, v183
v_pk_mul_f32 v[184:185], v[120:121], v[152:153]
v_pk_mul_f32 v[186:187], v[122:123], v[154:155]
v_pk_mul_f32 v[188:189], v[124:125], v[156:157]
v_pk_mul_f32 v[190:191], v[126:127], v[158:159]
v_pk_mul_f32 v[176:177], v[176:177], v[184:185]
v_pk_mul_f32 v[178:179], v[178:179], v[186:187]
v_pk_mul_f32 v[180:181], v[180:181], v[188:189]
v_pk_mul_f32 v[182:183], v[182:183], v[190:191]
v_cvt_pk_bf16_f32 v184, v176, v177
v_cvt_pk_bf16_f32 v185, v178, v179
v_xor_b32 v188, 32, v7
ds_write_b64 v188, v[184:185] offset:2048
v_cvt_pk_bf16_f32 v186, v180, v181
v_cvt_pk_bf16_f32 v187, v182, v183
v_xor_b32 v189, 48, v7
ds_write_b64 v189, v[186:187] offset:2048
s_waitcnt lgkmcnt(0)
ds_read_b128 v[160:163], v8 offset:0
ds_read_b128 v[164:167], v8 offset:1024
ds_read_b128 v[168:171], v8 offset:2048
ds_read_b128 v[172:175], v8 offset:3072
s_waitcnt lgkmcnt(3)
buffer_store_dwordx4 v[160:163], v9, s[16:19], s45 offen
s_add_u32 s45, s45, 77824
s_waitcnt lgkmcnt(2)
buffer_store_dwordx4 v[164:167], v9, s[16:19], s45 offen
s_add_u32 s45, s45, 77824
s_waitcnt lgkmcnt(1)
buffer_store_dwordx4 v[168:171], v9, s[16:19], s45 offen
s_add_u32 s45, s45, 77824
s_waitcnt lgkmcnt(0)
buffer_store_dwordx4 v[172:175], v9, s[16:19], s45 offen
s_add_u32 s45, s45, 77824
s_add_u32 s50, s50, 1
s_cmp_lt_u32 s50, s48
s_cbranch_scc1 L_s1c_tile
s_endpgm
L_s1_loader:
s_sub_u32 s3, s3, 4
s_lshl_b32 s28, s3, 12
s_cmp_ge_u32 s2, 128
s_cbranch_scc1 L_s1l_small
s_and_b32 s40, s2, 7
s_lshr_b32 s41, s2, 5
s_lshl_b32 s41, s41, 3
s_add_u32 s40, s40, s41
s_lshr_b32 s41, s2, 3
s_and_b32 s41, s41, 3
s_lshl_b32 s42, s41, 8
s_lshl_b32 s43, s3, 14
s_add_u32 s42, s42, s43
s_add_u32 s43, s42, 0
s_add_u32 s38, s4, s43
s_addc_u32 s39, s5, 0
s_sub_u32 s43, 2097152, s42
s_mov_b32 s8, s38
s_and_b32 s9, s39, 0xffff
s_mov_b32 s10, s43
s_mov_b32 s11, 0x00020000
s_cmp_ge_u32 s40, 16
s_cselect_b32 s6, s32, s6
s_cselect_b32 s7, s33, s7
s_and_b32 s45, s40, 15
s_lshl_b32 s42, s45, 7
s_lshl_b32 s43, s3, 5
s_add_u32 s42, s42, s43
s_lshl_b32 s42, s42, 12
s_add_u32 s38, s6, s42
s_addc_u32 s39, s7, 0
s_sub_u32 s43, 8388608, s42
s_mov_b32 s12, s38
s_and_b32 s13, s39, 0xffff
s_mov_b32 s14, s43
s_mov_b32 s15, 0x00020000
v_lshrrev_b32 v2, 3, v1
v_lshrrev_b32 v3, 4, v1
v_and_b32 v4, 7, v1
s_movk_i32 s29, 4096
v_add_u32 v5, 0, v2
v_mul_lo_u32 v5, v5, s29
v_add_u32 v6, 0, v3
v_and_b32 v6, 7, v6
v_xor_b32 v6, v6, v4
v_lshlrev_b32 v6, 4, v6
v_add_u32 v5, v5, v6
v_mov_b32 v10, v5
v_add_u32 v5, 8, v2
v_mul_lo_u32 v5, v5, s29
v_add_u32 v6, 4, v3
v_and_b32 v6, 7, v6
v_xor_b32 v6, v6, v4
v_lshlrev_b32 v6, 4, v6
v_add_u32 v5, v5, v6
v_subrev_u32 v5, 1024, v5
v_mov_b32 v11, v5
v_add_u32 v5, 16, v2
v_mul_lo_u32 v5, v5, s29
v_add_u32 v6, 8, v3
v_and_b32 v6, 7, v6
v_xor_b32 v6, v6, v4
v_lshlrev_b32 v6, 4, v6
v_add_u32 v5, v5, v6
v_subrev_u32 v5, 2048, v5
v_mov_b32 v12, v5
v_add_u32 v5, 24, v2
v_mul_lo_u32 v5, v5, s29
v_add_u32 v6, 12, v3
v_and_b32 v6, 7, v6
v_xor_b32 v6, v6, v4
v_lshlrev_b32 v6, 4, v6
v_add_u32 v5, v5, v6
v_subrev_u32 v5, 3072, v5
v_mov_b32 v13, v5
v_lshrrev_b32 v2, 4, v1
v_and_b32 v3, 15, v1
v_lshlrev_b32 v4, 2, v2
v_xor_b32 v3, v3, v4
v_lshlrev_b32 v3, 4, v3
s_movk_i32 s29, 1024
v_add_u32 v5, 0, v2
v_mul_lo_u32 v5, v5, s29
v_add_u32 v5, v5, v3
v_mov_b32 v16, v5
v_add_u32 v5, 4, v2
v_mul_lo_u32 v5, v5, s29
v_add_u32 v5, v5, v3
v_subrev_u32 v5, 1024, v5
v_mov_b32 v17, v5
v_add_u32 v5, 8, v2
v_mul_lo_u32 v5, v5, s29
v_add_u32 v5, v5, v3
v_subrev_u32 v5, 2048, v5
v_mov_b32 v18, v5
v_add_u32 v5, 12, v2
v_mul_lo_u32 v5, v5, s29
v_add_u32 v5, v5, v3
v_subrev_u32 v5, 3072, v5
v_mov_b32 v19, v5
s_add_u32 s24, s41, 0
s_and_b32 s24, s24, 3
s_lshl_b32 s24, s24, 3
s_add_u32 s24, s24, 0
s_lshl_b32 s25, s24, 7
s_lshl_b32 s24, s24, 16
s_add_u32 m0, s28, 0
s_nop 0
buffer_load_dwordx4 v16, s[8:11], s24 offen offset:0 lds
buffer_load_dwordx4 v17, s[8:11], s24 offen offset:1024 lds
buffer_load_dwordx4 v18, s[8:11], s24 offen offset:2048 lds
buffer_load_dwordx4 v19, s[8:11], s24 offen offset:3072 lds
s_add_u32 m0, s28, 16384
s_nop 0
buffer_load_dwordx4 v10, s[12:15], s25 offen offset:0 lds
buffer_load_dwordx4 v11, s[12:15], s25 offen offset:1024 lds
buffer_load_dwordx4 v12, s[12:15], s25 offen offset:2048 lds
buffer_load_dwordx4 v13, s[12:15], s25 offen offset:3072 lds
s_add_u32 s24, s41, 0
s_and_b32 s24, s24, 3
s_lshl_b32 s24, s24, 3
s_add_u32 s24, s24, 1
s_lshl_b32 s25, s24, 7
s_lshl_b32 s24, s24, 16
s_add_u32 m0, s28, 32768
s_nop 0
buffer_load_dwordx4 v16, s[8:11], s24 offen offset:0 lds
buffer_load_dwordx4 v17, s[8:11], s24 offen offset:1024 lds
buffer_load_dwordx4 v18, s[8:11], s24 offen offset:2048 lds
buffer_load_dwordx4 v19, s[8:11], s24 offen offset:3072 lds
s_add_u32 m0, s28, 49152
s_nop 0
buffer_load_dwordx4 v10, s[12:15], s25 offen offset:0 lds
buffer_load_dwordx4 v11, s[12:15], s25 offen offset:1024 lds
buffer_load_dwordx4 v12, s[12:15], s25 offen offset:2048 lds
buffer_load_dwordx4 v13, s[12:15], s25 offen offset:3072 lds
s_add_u32 s24, s41, 1
s_and_b32 s24, s24, 3
s_lshl_b32 s24, s24, 3
s_add_u32 s24, s24, 0
s_lshl_b32 s25, s24, 7
s_lshl_b32 s24, s24, 16
s_add_u32 m0, s28, 65536
s_nop 0
buffer_load_dwordx4 v16, s[8:11], s24 offen offset:0 lds
buffer_load_dwordx4 v17, s[8:11], s24 offen offset:1024 lds
buffer_load_dwordx4 v18, s[8:11], s24 offen offset:2048 lds
buffer_load_dwordx4 v19, s[8:11], s24 offen offset:3072 lds
s_add_u32 m0, s28, 81920
s_nop 0
buffer_load_dwordx4 v10, s[12:15], s25 offen offset:0 lds
buffer_load_dwordx4 v11, s[12:15], s25 offen offset:1024 lds
buffer_load_dwordx4 v12, s[12:15], s25 offen offset:2048 lds
buffer_load_dwordx4 v13, s[12:15], s25 offen offset:3072 lds
s_waitcnt vmcnt(16)
s_barrier
s_add_u32 s24, s41, 0
s_and_b32 s24, s24, 3
s_lshl_b32 s24, s24, 3
s_add_u32 s24, s24, 2
s_lshl_b32 s25, s24, 7
s_lshl_b32 s24, s24, 16
s_add_u32 m0, s28, 98304
s_nop 0
buffer_load_dwordx4 v16, s[8:11], s24 offen offset:0 lds
buffer_load_dwordx4 v17, s[8:11], s24 offen offset:1024 lds
buffer_load_dwordx4 v18, s[8:11], s24 offen offset:2048 lds
buffer_load_dwordx4 v19, s[8:11], s24 offen offset:3072 lds
s_add_u32 m0, s28, 114688
s_nop 0
buffer_load_dwordx4 v10, s[12:15], s25 offen offset:0 lds
buffer_load_dwordx4 v11, s[12:15], s25 offen offset:1024 lds
buffer_load_dwordx4 v12, s[12:15], s25 offen offset:2048 lds
buffer_load_dwordx4 v13, s[12:15], s25 offen offset:3072 lds
s_waitcnt vmcnt(16)
s_barrier
s_add_u32 s24, s41, 1
s_and_b32 s24, s24, 3
s_lshl_b32 s24, s24, 3
s_add_u32 s24, s24, 1
s_lshl_b32 s25, s24, 7
s_lshl_b32 s24, s24, 16
s_add_u32 m0, s28, 0
s_nop 0
buffer_load_dwordx4 v16, s[8:11], s24 offen offset:0 lds
buffer_load_dwordx4 v17, s[8:11], s24 offen offset:1024 lds
buffer_load_dwordx4 v18, s[8:11], s24 offen offset:2048 lds
buffer_load_dwordx4 v19, s[8:11], s24 offen offset:3072 lds
s_add_u32 m0, s28, 16384
s_nop 0
buffer_load_dwordx4 v10, s[12:15], s25 offen offset:0 lds
buffer_load_dwordx4 v11, s[12:15], s25 offen offset:1024 lds
buffer_load_dwordx4 v12, s[12:15], s25 offen offset:2048 lds
buffer_load_dwordx4 v13, s[12:15], s25 offen offset:3072 lds
s_waitcnt vmcnt(16)
s_barrier
s_add_u32 s24, s41, 0
s_and_b32 s24, s24, 3
s_lshl_b32 s24, s24, 3
s_add_u32 s24, s24, 3
s_lshl_b32 s25, s24, 7
s_lshl_b32 s24, s24, 16
s_add_u32 m0, s28, 32768
s_nop 0
buffer_load_dwordx4 v16, s[8:11], s24 offen offset:0 lds
buffer_load_dwordx4 v17, s[8:11], s24 offen offset:1024 lds
buffer_load_dwordx4 v18, s[8:11], s24 offen offset:2048 lds
buffer_load_dwordx4 v19, s[8:11], s24 offen offset:3072 lds
s_add_u32 m0, s28, 49152
s_nop 0
buffer_load_dwordx4 v10, s[12:15], s25 offen offset:0 lds
buffer_load_dwordx4 v11, s[12:15], s25 offen offset:1024 lds
buffer_load_dwordx4 v12, s[12:15], s25 offen offset:2048 lds
buffer_load_dwordx4 v13, s[12:15], s25 offen offset:3072 lds
s_waitcnt vmcnt(16)
s_barrier
s_add_u32 s24, s41, 1
s_and_b32 s24, s24, 3
s_lshl_b32 s24, s24, 3
s_add_u32 s24, s24, 2
s_lshl_b32 s25, s24, 7
s_lshl_b32 s24, s24, 16
s_add_u32 m0, s28, 65536
s_nop 0
buffer_load_dwordx4 v16, s[8:11], s24 offen offset:0 lds
buffer_load_dwordx4 v17, s[8:11], s24 offen offset:1024 lds
buffer_load_dwordx4 v18, s[8:11], s24 offen offset:2048 lds
buffer_load_dwordx4 v19, s[8:11], s24 offen offset:3072 lds
s_add_u32 m0, s28, 81920
s_nop 0
buffer_load_dwordx4 v10, s[12:15], s25 offen offset:0 lds
buffer_load_dwordx4 v11, s[12:15], s25 offen offset:1024 lds
buffer_load_dwordx4 v12, s[12:15], s25 offen offset:2048 lds
buffer_load_dwordx4 v13, s[12:15], s25 offen offset:3072 lds
s_waitcnt vmcnt(16)
s_barrier
s_add_u32 s24, s41, 0
s_and_b32 s24, s24, 3
s_lshl_b32 s24, s24, 3
s_add_u32 s24, s24, 4
s_lshl_b32 s25, s24, 7
s_lshl_b32 s24, s24, 16
s_add_u32 m0, s28, 98304
s_nop 0
buffer_load_dwordx4 v16, s[8:11], s24 offen offset:0 lds
buffer_load_dwordx4 v17, s[8:11], s24 offen offset:1024 lds
buffer_load_dwordx4 v18, s[8:11], s24 offen offset:2048 lds
buffer_load_dwordx4 v19, s[8:11], s24 offen offset:3072 lds
s_add_u32 m0, s28, 114688
s_nop 0
buffer_load_dwordx4 v10, s[12:15], s25 offen offset:0 lds
buffer_load_dwordx4 v11, s[12:15], s25 offen offset:1024 lds
buffer_load_dwordx4 v12, s[12:15], s25 offen offset:2048 lds
buffer_load_dwordx4 v13, s[12:15], s25 offen offset:3072 lds
s_waitcnt vmcnt(16)
s_barrier
s_add_u32 s24, s41, 1
s_and_b32 s24, s24, 3
s_lshl_b32 s24, s24, 3
s_add_u32 s24, s24, 3
s_lshl_b32 s25, s24, 7
s_lshl_b32 s24, s24, 16
s_add_u32 m0, s28, 0
s_nop 0
buffer_load_dwordx4 v16, s[8:11], s24 offen offset:0 lds
buffer_load_dwordx4 v17, s[8:11], s24 offen offset:1024 lds
buffer_load_dwordx4 v18, s[8:11], s24 offen offset:2048 lds
buffer_load_dwordx4 v19, s[8:11], s24 offen offset:3072 lds
s_add_u32 m0, s28, 16384
s_nop 0
buffer_load_dwordx4 v10, s[12:15], s25 offen offset:0 lds
buffer_load_dwordx4 v11, s[12:15], s25 offen offset:1024 lds
buffer_load_dwordx4 v12, s[12:15], s25 offen offset:2048 lds
buffer_load_dwordx4 v13, s[12:15], s25 offen offset:3072 lds
s_waitcnt vmcnt(16)
s_barrier
s_add_u32 s24, s41, 0
s_and_b32 s24, s24, 3
s_lshl_b32 s24, s24, 3
s_add_u32 s24, s24, 5
s_lshl_b32 s25, s24, 7
s_lshl_b32 s24, s24, 16
s_add_u32 m0, s28, 32768
s_nop 0
buffer_load_dwordx4 v16, s[8:11], s24 offen offset:0 lds
buffer_load_dwordx4 v17, s[8:11], s24 offen offset:1024 lds
buffer_load_dwordx4 v18, s[8:11], s24 offen offset:2048 lds
buffer_load_dwordx4 v19, s[8:11], s24 offen offset:3072 lds
s_add_u32 m0, s28, 49152
s_nop 0
buffer_load_dwordx4 v10, s[12:15], s25 offen offset:0 lds
buffer_load_dwordx4 v11, s[12:15], s25 offen offset:1024 lds
buffer_load_dwordx4 v12, s[12:15], s25 offen offset:2048 lds
buffer_load_dwordx4 v13, s[12:15], s25 offen offset:3072 lds
s_waitcnt vmcnt(16)
s_barrier
s_add_u32 s24, s41, 1
s_and_b32 s24, s24, 3
s_lshl_b32 s24, s24, 3
s_add_u32 s24, s24, 4
s_lshl_b32 s25, s24, 7
s_lshl_b32 s24, s24, 16
s_add_u32 m0, s28, 65536
s_nop 0
buffer_load_dwordx4 v16, s[8:11], s24 offen offset:0 lds
buffer_load_dwordx4 v17, s[8:11], s24 offen offset:1024 lds
buffer_load_dwordx4 v18, s[8:11], s24 offen offset:2048 lds
buffer_load_dwordx4 v19, s[8:11], s24 offen offset:3072 lds
s_add_u32 m0, s28, 81920
s_nop 0
buffer_load_dwordx4 v10, s[12:15], s25 offen offset:0 lds
buffer_load_dwordx4 v11, s[12:15], s25 offen offset:1024 lds
buffer_load_dwordx4 v12, s[12:15], s25 offen offset:2048 lds
buffer_load_dwordx4 v13, s[12:15], s25 offen offset:3072 lds
s_waitcnt vmcnt(16)
s_barrier
s_add_u32 s24, s41, 0
s_and_b32 s24, s24, 3
s_lshl_b32 s24, s24, 3
s_add_u32 s24, s24, 6
s_lshl_b32 s25, s24, 7
s_lshl_b32 s24, s24, 16
s_add_u32 m0, s28, 98304
s_nop 0
buffer_load_dwordx4 v16, s[8:11], s24 offen offset:0 lds
buffer_load_dwordx4 v17, s[8:11], s24 offen offset:1024 lds
buffer_load_dwordx4 v18, s[8:11], s24 offen offset:2048 lds
buffer_load_dwordx4 v19, s[8:11], s24 offen offset:3072 lds
s_add_u32 m0, s28, 114688
s_nop 0
buffer_load_dwordx4 v10, s[12:15], s25 offen offset:0 lds
buffer_load_dwordx4 v11, s[12:15], s25 offen offset:1024 lds
buffer_load_dwordx4 v12, s[12:15], s25 offen offset:2048 lds
buffer_load_dwordx4 v13, s[12:15], s25 offen offset:3072 lds
s_waitcnt vmcnt(16)
s_barrier
s_add_u32 s24, s41, 1
s_and_b32 s24, s24, 3
s_lshl_b32 s24, s24, 3
s_add_u32 s24, s24, 5
s_lshl_b32 s25, s24, 7
s_lshl_b32 s24, s24, 16
s_add_u32 m0, s28, 0
s_nop 0
buffer_load_dwordx4 v16, s[8:11], s24 offen offset:0 lds
buffer_load_dwordx4 v17, s[8:11], s24 offen offset:1024 lds
buffer_load_dwordx4 v18, s[8:11], s24 offen offset:2048 lds
buffer_load_dwordx4 v19, s[8:11], s24 offen offset:3072 lds
s_add_u32 m0, s28, 16384
s_nop 0
buffer_load_dwordx4 v10, s[12:15], s25 offen offset:0 lds
buffer_load_dwordx4 v11, s[12:15], s25 offen offset:1024 lds
buffer_load_dwordx4 v12, s[12:15], s25 offen offset:2048 lds
buffer_load_dwordx4 v13, s[12:15], s25 offen offset:3072 lds
s_waitcnt vmcnt(16)
s_barrier
s_add_u32 s24, s41, 0
s_and_b32 s24, s24, 3
s_lshl_b32 s24, s24, 3
s_add_u32 s24, s24, 7
s_lshl_b32 s25, s24, 7
s_lshl_b32 s24, s24, 16
s_add_u32 m0, s28, 32768
s_nop 0
buffer_load_dwordx4 v16, s[8:11], s24 offen offset:0 lds
buffer_load_dwordx4 v17, s[8:11], s24 offen offset:1024 lds
buffer_load_dwordx4 v18, s[8:11], s24 offen offset:2048 lds
buffer_load_dwordx4 v19, s[8:11], s24 offen offset:3072 lds
s_add_u32 m0, s28, 49152
s_nop 0
buffer_load_dwordx4 v10, s[12:15], s25 offen offset:0 lds
buffer_load_dwordx4 v11, s[12:15], s25 offen offset:1024 lds
buffer_load_dwordx4 v12, s[12:15], s25 offen offset:2048 lds
buffer_load_dwordx4 v13, s[12:15], s25 offen offset:3072 lds
s_waitcnt vmcnt(16)
s_barrier
s_add_u32 s24, s41, 1
s_and_b32 s24, s24, 3
s_lshl_b32 s24, s24, 3
s_add_u32 s24, s24, 6
s_lshl_b32 s25, s24, 7
s_lshl_b32 s24, s24, 16
s_add_u32 m0, s28, 65536
s_nop 0
buffer_load_dwordx4 v16, s[8:11], s24 offen offset:0 lds
buffer_load_dwordx4 v17, s[8:11], s24 offen offset:1024 lds
buffer_load_dwordx4 v18, s[8:11], s24 offen offset:2048 lds
buffer_load_dwordx4 v19, s[8:11], s24 offen offset:3072 lds
s_add_u32 m0, s28, 81920
s_nop 0
buffer_load_dwordx4 v10, s[12:15], s25 offen offset:0 lds
buffer_load_dwordx4 v11, s[12:15], s25 offen offset:1024 lds
buffer_load_dwordx4 v12, s[12:15], s25 offen offset:2048 lds
buffer_load_dwordx4 v13, s[12:15], s25 offen offset:3072 lds
s_waitcnt vmcnt(16)
s_barrier
s_add_u32 s24, s41, 1
s_and_b32 s24, s24, 3
s_lshl_b32 s24, s24, 3
s_add_u32 s24, s24, 7
s_lshl_b32 s25, s24, 7
s_lshl_b32 s24, s24, 16
s_add_u32 m0, s28, 98304
s_nop 0
buffer_load_dwordx4 v16, s[8:11], s24 offen offset:0 lds
buffer_load_dwordx4 v17, s[8:11], s24 offen offset:1024 lds
buffer_load_dwordx4 v18, s[8:11], s24 offen offset:2048 lds
buffer_load_dwordx4 v19, s[8:11], s24 offen offset:3072 lds
s_add_u32 m0, s28, 114688
s_nop 0
buffer_load_dwordx4 v10, s[12:15], s25 offen offset:0 lds
buffer_load_dwordx4 v11, s[12:15], s25 offen offset:1024 lds
buffer_load_dwordx4 v12, s[12:15], s25 offen offset:2048 lds
buffer_load_dwordx4 v13, s[12:15], s25 offen offset:3072 lds
s_waitcnt vmcnt(16)
s_barrier
s_add_u32 s24, s41, 2
s_and_b32 s24, s24, 3
s_lshl_b32 s24, s24, 3
s_add_u32 s24, s24, 0
s_lshl_b32 s25, s24, 7
s_lshl_b32 s24, s24, 16
s_add_u32 m0, s28, 0
s_nop 0
buffer_load_dwordx4 v16, s[8:11], s24 offen offset:0 lds
buffer_load_dwordx4 v17, s[8:11], s24 offen offset:1024 lds
buffer_load_dwordx4 v18, s[8:11], s24 offen offset:2048 lds
buffer_load_dwordx4 v19, s[8:11], s24 offen offset:3072 lds
s_add_u32 m0, s28, 16384
s_nop 0
buffer_load_dwordx4 v10, s[12:15], s25 offen offset:0 lds
buffer_load_dwordx4 v11, s[12:15], s25 offen offset:1024 lds
buffer_load_dwordx4 v12, s[12:15], s25 offen offset:2048 lds
buffer_load_dwordx4 v13, s[12:15], s25 offen offset:3072 lds
s_waitcnt vmcnt(16)
s_barrier
s_add_u32 s24, s41, 2
s_and_b32 s24, s24, 3
s_lshl_b32 s24, s24, 3
s_add_u32 s24, s24, 1
s_lshl_b32 s25, s24, 7
s_lshl_b32 s24, s24, 16
s_add_u32 m0, s28, 32768
s_nop 0
buffer_load_dwordx4 v16, s[8:11], s24 offen offset:0 lds
buffer_load_dwordx4 v17, s[8:11], s24 offen offset:1024 lds
buffer_load_dwordx4 v18, s[8:11], s24 offen offset:2048 lds
buffer_load_dwordx4 v19, s[8:11], s24 offen offset:3072 lds
s_add_u32 m0, s28, 49152
s_nop 0
buffer_load_dwordx4 v10, s[12:15], s25 offen offset:0 lds
buffer_load_dwordx4 v11, s[12:15], s25 offen offset:1024 lds
buffer_load_dwordx4 v12, s[12:15], s25 offen offset:2048 lds
buffer_load_dwordx4 v13, s[12:15], s25 offen offset:3072 lds
s_waitcnt vmcnt(16)
s_barrier
s_add_u32 s24, s41, 2
s_and_b32 s24, s24, 3
s_lshl_b32 s24, s24, 3
s_add_u32 s24, s24, 2
s_lshl_b32 s25, s24, 7
s_lshl_b32 s24, s24, 16
s_add_u32 m0, s28, 65536
s_nop 0
buffer_load_dwordx4 v16, s[8:11], s24 offen offset:0 lds
buffer_load_dwordx4 v17, s[8:11], s24 offen offset:1024 lds
buffer_load_dwordx4 v18, s[8:11], s24 offen offset:2048 lds
buffer_load_dwordx4 v19, s[8:11], s24 offen offset:3072 lds
s_add_u32 m0, s28, 81920
s_nop 0
buffer_load_dwordx4 v10, s[12:15], s25 offen offset:0 lds
buffer_load_dwordx4 v11, s[12:15], s25 offen offset:1024 lds
buffer_load_dwordx4 v12, s[12:15], s25 offen offset:2048 lds
buffer_load_dwordx4 v13, s[12:15], s25 offen offset:3072 lds
s_waitcnt vmcnt(16)
s_barrier
s_add_u32 s24, s41, 2
s_and_b32 s24, s24, 3
s_lshl_b32 s24, s24, 3
s_add_u32 s24, s24, 3
s_lshl_b32 s25, s24, 7
s_lshl_b32 s24, s24, 16
s_add_u32 m0, s28, 98304
s_nop 0
buffer_load_dwordx4 v16, s[8:11], s24 offen offset:0 lds
buffer_load_dwordx4 v17, s[8:11], s24 offen offset:1024 lds
buffer_load_dwordx4 v18, s[8:11], s24 offen offset:2048 lds
buffer_load_dwordx4 v19, s[8:11], s24 offen offset:3072 lds
s_add_u32 m0, s28, 114688
s_nop 0
buffer_load_dwordx4 v10, s[12:15], s25 offen offset:0 lds
buffer_load_dwordx4 v11, s[12:15], s25 offen offset:1024 lds
buffer_load_dwordx4 v12, s[12:15], s25 offen offset:2048 lds
buffer_load_dwordx4 v13, s[12:15], s25 offen offset:3072 lds
s_waitcnt vmcnt(16)
s_barrier
s_add_u32 s24, s41, 2
s_and_b32 s24, s24, 3
s_lshl_b32 s24, s24, 3
s_add_u32 s24, s24, 4
s_lshl_b32 s25, s24, 7
s_lshl_b32 s24, s24, 16
s_add_u32 m0, s28, 0
s_nop 0
buffer_load_dwordx4 v16, s[8:11], s24 offen offset:0 lds
buffer_load_dwordx4 v17, s[8:11], s24 offen offset:1024 lds
buffer_load_dwordx4 v18, s[8:11], s24 offen offset:2048 lds
buffer_load_dwordx4 v19, s[8:11], s24 offen offset:3072 lds
s_add_u32 m0, s28, 16384
s_nop 0
buffer_load_dwordx4 v10, s[12:15], s25 offen offset:0 lds
buffer_load_dwordx4 v11, s[12:15], s25 offen offset:1024 lds
buffer_load_dwordx4 v12, s[12:15], s25 offen offset:2048 lds
buffer_load_dwordx4 v13, s[12:15], s25 offen offset:3072 lds
s_waitcnt vmcnt(16)
s_barrier
s_add_u32 s24, s41, 2
s_and_b32 s24, s24, 3
s_lshl_b32 s24, s24, 3
s_add_u32 s24, s24, 5
s_lshl_b32 s25, s24, 7
s_lshl_b32 s24, s24, 16
s_add_u32 m0, s28, 32768
s_nop 0
buffer_load_dwordx4 v16, s[8:11], s24 offen offset:0 lds
buffer_load_dwordx4 v17, s[8:11], s24 offen offset:1024 lds
buffer_load_dwordx4 v18, s[8:11], s24 offen offset:2048 lds
buffer_load_dwordx4 v19, s[8:11], s24 offen offset:3072 lds
s_add_u32 m0, s28, 49152
s_nop 0
buffer_load_dwordx4 v10, s[12:15], s25 offen offset:0 lds
buffer_load_dwordx4 v11, s[12:15], s25 offen offset:1024 lds
buffer_load_dwordx4 v12, s[12:15], s25 offen offset:2048 lds
buffer_load_dwordx4 v13, s[12:15], s25 offen offset:3072 lds
s_waitcnt vmcnt(16)
s_barrier
s_add_u32 s24, s41, 2
s_and_b32 s24, s24, 3
s_lshl_b32 s24, s24, 3
s_add_u32 s24, s24, 6
s_lshl_b32 s25, s24, 7
s_lshl_b32 s24, s24, 16
s_add_u32 m0, s28, 65536
s_nop 0
buffer_load_dwordx4 v16, s[8:11], s24 offen offset:0 lds
buffer_load_dwordx4 v17, s[8:11], s24 offen offset:1024 lds
buffer_load_dwordx4 v18, s[8:11], s24 offen offset:2048 lds
buffer_load_dwordx4 v19, s[8:11], s24 offen offset:3072 lds
s_add_u32 m0, s28, 81920
s_nop 0
buffer_load_dwordx4 v10, s[12:15], s25 offen offset:0 lds
buffer_load_dwordx4 v11, s[12:15], s25 offen offset:1024 lds
buffer_load_dwordx4 v12, s[12:15], s25 offen offset:2048 lds
buffer_load_dwordx4 v13, s[12:15], s25 offen offset:3072 lds
s_waitcnt vmcnt(16)
s_barrier
s_add_u32 s24, s41, 2
s_and_b32 s24, s24, 3
s_lshl_b32 s24, s24, 3
s_add_u32 s24, s24, 7
s_lshl_b32 s25, s24, 7
s_lshl_b32 s24, s24, 16
s_add_u32 m0, s28, 98304
s_nop 0
buffer_load_dwordx4 v16, s[8:11], s24 offen offset:0 lds
buffer_load_dwordx4 v17, s[8:11], s24 offen offset:1024 lds
buffer_load_dwordx4 v18, s[8:11], s24 offen offset:2048 lds
buffer_load_dwordx4 v19, s[8:11], s24 offen offset:3072 lds
s_add_u32 m0, s28, 114688
s_nop 0
buffer_load_dwordx4 v10, s[12:15], s25 offen offset:0 lds
buffer_load_dwordx4 v11, s[12:15], s25 offen offset:1024 lds
buffer_load_dwordx4 v12, s[12:15], s25 offen offset:2048 lds
buffer_load_dwordx4 v13, s[12:15], s25 offen offset:3072 lds
s_waitcnt vmcnt(16)
s_barrier
s_add_u32 s24, s41, 3
s_and_b32 s24, s24, 3
s_lshl_b32 s24, s24, 3
s_add_u32 s24, s24, 0
s_lshl_b32 s25, s24, 7
s_lshl_b32 s24, s24, 16
s_add_u32 m0, s28, 0
s_nop 0
buffer_load_dwordx4 v16, s[8:11], s24 offen offset:0 lds
buffer_load_dwordx4 v17, s[8:11], s24 offen offset:1024 lds
buffer_load_dwordx4 v18, s[8:11], s24 offen offset:2048 lds
buffer_load_dwordx4 v19, s[8:11], s24 offen offset:3072 lds
s_add_u32 m0, s28, 16384
s_nop 0
buffer_load_dwordx4 v10, s[12:15], s25 offen offset:0 lds
buffer_load_dwordx4 v11, s[12:15], s25 offen offset:1024 lds
buffer_load_dwordx4 v12, s[12:15], s25 offen offset:2048 lds
buffer_load_dwordx4 v13, s[12:15], s25 offen offset:3072 lds
s_waitcnt vmcnt(16)
s_barrier
s_add_u32 s24, s41, 3
s_and_b32 s24, s24, 3
s_lshl_b32 s24, s24, 3
s_add_u32 s24, s24, 1
s_lshl_b32 s25, s24, 7
s_lshl_b32 s24, s24, 16
s_add_u32 m0, s28, 32768
s_nop 0
buffer_load_dwordx4 v16, s[8:11], s24 offen offset:0 lds
buffer_load_dwordx4 v17, s[8:11], s24 offen offset:1024 lds
buffer_load_dwordx4 v18, s[8:11], s24 offen offset:2048 lds
buffer_load_dwordx4 v19, s[8:11], s24 offen offset:3072 lds
s_add_u32 m0, s28, 49152
s_nop 0
buffer_load_dwordx4 v10, s[12:15], s25 offen offset:0 lds
buffer_load_dwordx4 v11, s[12:15], s25 offen offset:1024 lds
buffer_load_dwordx4 v12, s[12:15], s25 offen offset:2048 lds
buffer_load_dwordx4 v13, s[12:15], s25 offen offset:3072 lds
s_waitcnt vmcnt(16)
s_barrier
s_add_u32 s24, s41, 3
s_and_b32 s24, s24, 3
s_lshl_b32 s24, s24, 3
s_add_u32 s24, s24, 2
s_lshl_b32 s25, s24, 7
s_lshl_b32 s24, s24, 16
s_add_u32 m0, s28, 65536
s_nop 0
buffer_load_dwordx4 v16, s[8:11], s24 offen offset:0 lds
buffer_load_dwordx4 v17, s[8:11], s24 offen offset:1024 lds
buffer_load_dwordx4 v18, s[8:11], s24 offen offset:2048 lds
buffer_load_dwordx4 v19, s[8:11], s24 offen offset:3072 lds
s_add_u32 m0, s28, 81920
s_nop 0
buffer_load_dwordx4 v10, s[12:15], s25 offen offset:0 lds
buffer_load_dwordx4 v11, s[12:15], s25 offen offset:1024 lds
buffer_load_dwordx4 v12, s[12:15], s25 offen offset:2048 lds
buffer_load_dwordx4 v13, s[12:15], s25 offen offset:3072 lds
s_waitcnt vmcnt(16)
s_barrier
s_add_u32 s24, s41, 3
s_and_b32 s24, s24, 3
s_lshl_b32 s24, s24, 3
s_add_u32 s24, s24, 3
s_lshl_b32 s25, s24, 7
s_lshl_b32 s24, s24, 16
s_add_u32 m0, s28, 98304
s_nop 0
buffer_load_dwordx4 v16, s[8:11], s24 offen offset:0 lds
buffer_load_dwordx4 v17, s[8:11], s24 offen offset:1024 lds
buffer_load_dwordx4 v18, s[8:11], s24 offen offset:2048 lds
buffer_load_dwordx4 v19, s[8:11], s24 offen offset:3072 lds
s_add_u32 m0, s28, 114688
s_nop 0
buffer_load_dwordx4 v10, s[12:15], s25 offen offset:0 lds
buffer_load_dwordx4 v11, s[12:15], s25 offen offset:1024 lds
buffer_load_dwordx4 v12, s[12:15], s25 offen offset:2048 lds
buffer_load_dwordx4 v13, s[12:15], s25 offen offset:3072 lds
s_waitcnt vmcnt(16)
s_barrier
s_add_u32 s24, s41, 3
s_and_b32 s24, s24, 3
s_lshl_b32 s24, s24, 3
s_add_u32 s24, s24, 4
s_lshl_b32 s25, s24, 7
s_lshl_b32 s24, s24, 16
s_add_u32 m0, s28, 0
s_nop 0
buffer_load_dwordx4 v16, s[8:11], s24 offen offset:0 lds
buffer_load_dwordx4 v17, s[8:11], s24 offen offset:1024 lds
buffer_load_dwordx4 v18, s[8:11], s24 offen offset:2048 lds
buffer_load_dwordx4 v19, s[8:11], s24 offen offset:3072 lds
s_add_u32 m0, s28, 16384
s_nop 0
buffer_load_dwordx4 v10, s[12:15], s25 offen offset:0 lds
buffer_load_dwordx4 v11, s[12:15], s25 offen offset:1024 lds
buffer_load_dwordx4 v12, s[12:15], s25 offen offset:2048 lds
buffer_load_dwordx4 v13, s[12:15], s25 offen offset:3072 lds
s_waitcnt vmcnt(16)
s_barrier
s_add_u32 s24, s41, 3
s_and_b32 s24, s24, 3
s_lshl_b32 s24, s24, 3
s_add_u32 s24, s24, 5
s_lshl_b32 s25, s24, 7
s_lshl_b32 s24, s24, 16
s_add_u32 m0, s28, 32768
s_nop 0
buffer_load_dwordx4 v16, s[8:11], s24 offen offset:0 lds
buffer_load_dwordx4 v17, s[8:11], s24 offen offset:1024 lds
buffer_load_dwordx4 v18, s[8:11], s24 offen offset:2048 lds
buffer_load_dwordx4 v19, s[8:11], s24 offen offset:3072 lds
s_add_u32 m0, s28, 49152
s_nop 0
buffer_load_dwordx4 v10, s[12:15], s25 offen offset:0 lds
buffer_load_dwordx4 v11, s[12:15], s25 offen offset:1024 lds
buffer_load_dwordx4 v12, s[12:15], s25 offen offset:2048 lds
buffer_load_dwordx4 v13, s[12:15], s25 offen offset:3072 lds
s_waitcnt vmcnt(16)
s_barrier
s_add_u32 s24, s41, 3
s_and_b32 s24, s24, 3
s_lshl_b32 s24, s24, 3
s_add_u32 s24, s24, 6
s_lshl_b32 s25, s24, 7
s_lshl_b32 s24, s24, 16
s_add_u32 m0, s28, 65536
s_nop 0
buffer_load_dwordx4 v16, s[8:11], s24 offen offset:0 lds
buffer_load_dwordx4 v17, s[8:11], s24 offen offset:1024 lds
buffer_load_dwordx4 v18, s[8:11], s24 offen offset:2048 lds
buffer_load_dwordx4 v19, s[8:11], s24 offen offset:3072 lds
s_add_u32 m0, s28, 81920
s_nop 0
buffer_load_dwordx4 v10, s[12:15], s25 offen offset:0 lds
buffer_load_dwordx4 v11, s[12:15], s25 offen offset:1024 lds
buffer_load_dwordx4 v12, s[12:15], s25 offen offset:2048 lds
buffer_load_dwordx4 v13, s[12:15], s25 offen offset:3072 lds
s_waitcnt vmcnt(16)
s_barrier
s_add_u32 s24, s41, 3
s_and_b32 s24, s24, 3
s_lshl_b32 s24, s24, 3
s_add_u32 s24, s24, 7
s_lshl_b32 s25, s24, 7
s_lshl_b32 s24, s24, 16
s_add_u32 m0, s28, 98304
s_nop 0
buffer_load_dwordx4 v16, s[8:11], s24 offen offset:0 lds
buffer_load_dwordx4 v17, s[8:11], s24 offen offset:1024 lds
buffer_load_dwordx4 v18, s[8:11], s24 offen offset:2048 lds
buffer_load_dwordx4 v19, s[8:11], s24 offen offset:3072 lds
s_add_u32 m0, s28, 114688
s_nop 0
buffer_load_dwordx4 v10, s[12:15], s25 offen offset:0 lds
buffer_load_dwordx4 v11, s[12:15], s25 offen offset:1024 lds
buffer_load_dwordx4 v12, s[12:15], s25 offen offset:2048 lds
buffer_load_dwordx4 v13, s[12:15], s25 offen offset:3072 lds
s_waitcnt vmcnt(16)
s_barrier
s_waitcnt vmcnt(8)
s_barrier
s_waitcnt vmcnt(0)
s_barrier
s_endpgm
L_s1l_small:
s_mov_b32 s50, 0
s_sub_u32 s42, s2, 128
s_and_b32 s43, s42, 7
s_lshr_b32 s42, s42, 3
s_lshl_b32 s44, s50, 4
s_add_u32 s42, s42, s44
s_lshr_b32 s40, s42, 1
s_and_b32 s42, s42, 1
s_lshl_b32 s41, s43, 1
s_add_u32 s41, s41, s42
s_lshr_b32 s42, s3, 1
s_cmp_eq_u32 s42, 1
s_cselect_b32 s60, s58, s56
s_cselect_b32 s61, s59, s57
s_and_b32 s42, s3, 1
s_mul_i32 s42, s42, 88064
s_lshl_b32 s43, s40, 7
s_add_u32 s42, s42, s43
s_add_u32 s38, s60, s42
s_addc_u32 s39, s61, 0
s_sub_u32 s43, 1409024, s42
s_mov_b32 s8, s38
s_and_b32 s9, s39, 0xffff
s_mov_b32 s10, s43
s_mov_b32 s11, 0x00020000
s_lshl_b32 s42, s41, 7
s_lshl_b32 s43, s3, 5
s_add_u32 s42, s42, s43
s_lshl_b32 s42, s42, 10
s_add_u32 s43, s42, 0
s_add_u32 s38, s4, s43
s_addc_u32 s39, s5, 0
s_sub_u32 s43, 2097152, s42
s_mov_b32 s12, s38
s_and_b32 s13, s39, 0xffff
s_mov_b32 s14, s43
s_mov_b32 s15, 0x00020000
s_mov_b32 s24, 0
s_mov_b32 s25, 0
v_lshrrev_b32 v2, 3, v1
v_lshrrev_b32 v3, 4, v1
v_and_b32 v4, 7, v1
s_movk_i32 s29, 1024
v_add_u32 v5, 0, v2
v_mul_lo_u32 v5, v5, s29
v_add_u32 v6, 0, v3
v_and_b32 v6, 7, v6
v_xor_b32 v6, v6, v4
v_lshlrev_b32 v6, 4, v6
v_add_u32 v5, v5, v6
v_mov_b32 v10, v5
v_add_u32 v5, 8, v2
v_mul_lo_u32 v5, v5, s29
v_add_u32 v6, 4, v3
v_and_b32 v6, 7, v6
v_xor_b32 v6, v6, v4
v_lshlrev_b32 v6, 4, v6
v_add_u32 v5, v5, v6
v_subrev_u32 v5, 1024, v5
v_mov_b32 v11, v5
v_add_u32 v5, 16, v2
v_mul_lo_u32 v5, v5, s29
v_add_u32 v6, 8, v3
v_and_b32 v6, 7, v6
v_xor_b32 v6, v6, v4
v_lshlrev_b32 v6, 4, v6
v_add_u32 v5, v5, v6
v_subrev_u32 v5, 2048, v5
v_mov_b32 v12, v5
v_add_u32 v5, 24, v2
v_mul_lo_u32 v5, v5, s29
v_add_u32 v6, 12, v3
v_and_b32 v6, 7, v6
v_xor_b32 v6, v6, v4
v_lshlrev_b32 v6, 4, v6
v_add_u32 v5, v5, v6
v_subrev_u32 v5, 3072, v5
v_mov_b32 v13, v5
v_lshrrev_b32 v2, 3, v1
v_and_b32 v3, 7, v1
v_lshrrev_b32 v4, 4, v1
v_and_b32 v4, 1, v4
v_lshlrev_b32 v4, 2, v4
v_xor_b32 v3, v3, v4
v_lshlrev_b32 v3, 4, v3
s_movk_i32 s29, 2752
v_add_u32 v5, 0, v2
v_mul_lo_u32 v5, v5, s29
v_add_u32 v5, v5, v3
v_mov_b32 v16, v5
v_add_u32 v5, 8, v2
v_mul_lo_u32 v5, v5, s29
v_add_u32 v5, v5, v3
v_subrev_u32 v5, 1024, v5
v_mov_b32 v17, v5
v_add_u32 v5, 16, v2
v_mul_lo_u32 v5, v5, s29
v_add_u32 v5, v5, v3
v_subrev_u32 v5, 2048, v5
v_mov_b32 v18, v5
v_add_u32 v5, 24, v2
v_mul_lo_u32 v5, v5, s29
v_add_u32 v5, v5, v3
v_subrev_u32 v5, 3072, v5
v_mov_b32 v19, v5
s_add_u32 m0, s28, 0
s_nop 0
buffer_load_dwordx4 v16, s[8:11], s24 offen offset:0 lds
buffer_load_dwordx4 v17, s[8:11], s24 offen offset:1024 lds
buffer_load_dwordx4 v18, s[8:11], s24 offen offset:2048 lds
buffer_load_dwordx4 v19, s[8:11], s24 offen offset:3072 lds
s_add_u32 m0, s28, 16384
s_nop 0
buffer_load_dwordx4 v10, s[12:15], s25 offen offset:0 lds
buffer_load_dwordx4 v11, s[12:15], s25 offen offset:1024 lds
buffer_load_dwordx4 v12, s[12:15], s25 offen offset:2048 lds
buffer_load_dwordx4 v13, s[12:15], s25 offen offset:3072 lds
s_add_u32 s24, s24, 176128
s_add_u32 s25, s25, 128
s_add_u32 m0, s28, 32768
s_nop 0
buffer_load_dwordx4 v16, s[8:11], s24 offen offset:0 lds
buffer_load_dwordx4 v17, s[8:11], s24 offen offset:1024 lds
buffer_load_dwordx4 v18, s[8:11], s24 offen offset:2048 lds
buffer_load_dwordx4 v19, s[8:11], s24 offen offset:3072 lds
s_add_u32 m0, s28, 49152
s_nop 0
buffer_load_dwordx4 v10, s[12:15], s25 offen offset:0 lds
buffer_load_dwordx4 v11, s[12:15], s25 offen offset:1024 lds
buffer_load_dwordx4 v12, s[12:15], s25 offen offset:2048 lds
buffer_load_dwordx4 v13, s[12:15], s25 offen offset:3072 lds
s_add_u32 s24, s24, 176128
s_add_u32 s25, s25, 128
s_add_u32 m0, s28, 65536
s_nop 0
buffer_load_dwordx4 v16, s[8:11], s24 offen offset:0 lds
buffer_load_dwordx4 v17, s[8:11], s24 offen offset:1024 lds
buffer_load_dwordx4 v18, s[8:11], s24 offen offset:2048 lds
buffer_load_dwordx4 v19, s[8:11], s24 offen offset:3072 lds
s_add_u32 m0, s28, 81920
s_nop 0
buffer_load_dwordx4 v10, s[12:15], s25 offen offset:0 lds
buffer_load_dwordx4 v11, s[12:15], s25 offen offset:1024 lds
buffer_load_dwordx4 v12, s[12:15], s25 offen offset:2048 lds
buffer_load_dwordx4 v13, s[12:15], s25 offen offset:3072 lds
s_add_u32 s24, s24, 176128
s_add_u32 s25, s25, 128
s_lshl_b32 s26, s48, 1
s_sub_u32 s26, s26, 1
L_s1l_small_loop:
s_waitcnt vmcnt(16)
s_barrier
s_add_u32 m0, s28, 98304
s_nop 0
buffer_load_dwordx4 v16, s[8:11], s24 offen offset:0 lds
buffer_load_dwordx4 v17, s[8:11], s24 offen offset:1024 lds
buffer_load_dwordx4 v18, s[8:11], s24 offen offset:2048 lds
buffer_load_dwordx4 v19, s[8:11], s24 offen offset:3072 lds
s_add_u32 m0, s28, 114688
s_nop 0
buffer_load_dwordx4 v10, s[12:15], s25 offen offset:0 lds
buffer_load_dwordx4 v11, s[12:15], s25 offen offset:1024 lds
buffer_load_dwordx4 v12, s[12:15], s25 offen offset:2048 lds
buffer_load_dwordx4 v13, s[12:15], s25 offen offset:3072 lds
s_add_u32 s24, s24, 176128
s_add_u32 s25, s25, 128
s_waitcnt vmcnt(16)
s_barrier
s_cmp_lt_u32 s25, 1024
s_cbranch_scc1 L_s1l_same
s_add_u32 s50, s50, 1
s_sub_u32 s42, s2, 128
s_and_b32 s43, s42, 7
s_lshr_b32 s42, s42, 3
s_lshl_b32 s44, s50, 4
s_add_u32 s42, s42, s44
s_lshr_b32 s40, s42, 1
s_and_b32 s42, s42, 1
s_lshl_b32 s41, s43, 1
s_add_u32 s41, s41, s42
s_lshr_b32 s42, s3, 1
s_cmp_eq_u32 s42, 1
s_cselect_b32 s60, s58, s56
s_cselect_b32 s61, s59, s57
s_and_b32 s42, s3, 1
s_mul_i32 s42, s42, 88064
s_lshl_b32 s43, s40, 7
s_add_u32 s42, s42, s43
s_add_u32 s38, s60, s42
s_addc_u32 s39, s61, 0
s_sub_u32 s43, 1409024, s42
s_mov_b32 s8, s38
s_and_b32 s9, s39, 0xffff
s_mov_b32 s10, s43
s_mov_b32 s11, 0x00020000
s_lshl_b32 s42, s41, 7
s_lshl_b32 s43, s3, 5
s_add_u32 s42, s42, s43
s_lshl_b32 s42, s42, 10
s_add_u32 s43, s42, 0
s_add_u32 s38, s4, s43
s_addc_u32 s39, s5, 0
s_sub_u32 s43, 2097152, s42
s_mov_b32 s12, s38
s_and_b32 s13, s39, 0xffff
s_mov_b32 s14, s43
s_mov_b32 s15, 0x00020000
s_mov_b32 s24, 0
s_mov_b32 s25, 0
L_s1l_same:
s_add_u32 m0, s28, 0
s_nop 0
buffer_load_dwordx4 v16, s[8:11], s24 offen offset:0 lds
buffer_load_dwordx4 v17, s[8:11], s24 offen offset:1024 lds
buffer_load_dwordx4 v18, s[8:11], s24 offen offset:2048 lds
buffer_load_dwordx4 v19, s[8:11], s24 offen offset:3072 lds
s_add_u32 m0, s28, 16384
s_nop 0
buffer_load_dwordx4 v10, s[12:15], s25 offen offset:0 lds
buffer_load_dwordx4 v11, s[12:15], s25 offen offset:1024 lds
buffer_load_dwordx4 v12, s[12:15], s25 offen offset:2048 lds
buffer_load_dwordx4 v13, s[12:15], s25 offen offset:3072 lds
s_add_u32 s24, s24, 176128
s_add_u32 s25, s25, 128
s_waitcnt vmcnt(16)
s_barrier
s_add_u32 m0, s28, 32768
s_nop 0
buffer_load_dwordx4 v16, s[8:11], s24 offen offset:0 lds
buffer_load_dwordx4 v17, s[8:11], s24 offen offset:1024 lds
buffer_load_dwordx4 v18, s[8:11], s24 offen offset:2048 lds
buffer_load_dwordx4 v19, s[8:11], s24 offen offset:3072 lds
s_add_u32 m0, s28, 49152
s_nop 0
buffer_load_dwordx4 v10, s[12:15], s25 offen offset:0 lds
buffer_load_dwordx4 v11, s[12:15], s25 offen offset:1024 lds
buffer_load_dwordx4 v12, s[12:15], s25 offen offset:2048 lds
buffer_load_dwordx4 v13, s[12:15], s25 offen offset:3072 lds
s_add_u32 s24, s24, 176128
s_add_u32 s25, s25, 128
s_waitcnt vmcnt(16)
s_barrier
s_add_u32 m0, s28, 65536
s_nop 0
buffer_load_dwordx4 v16, s[8:11], s24 offen offset:0 lds
buffer_load_dwordx4 v17, s[8:11], s24 offen offset:1024 lds
buffer_load_dwordx4 v18, s[8:11], s24 offen offset:2048 lds
buffer_load_dwordx4 v19, s[8:11], s24 offen offset:3072 lds
s_add_u32 m0, s28, 81920
s_nop 0
buffer_load_dwordx4 v10, s[12:15], s25 offen offset:0 lds
buffer_load_dwordx4 v11, s[12:15], s25 offen offset:1024 lds
buffer_load_dwordx4 v12, s[12:15], s25 offen offset:2048 lds
buffer_load_dwordx4 v13, s[12:15], s25 offen offset:3072 lds
s_add_u32 s24, s24, 176128
s_add_u32 s25, s25, 128
s_sub_u32 s26, s26, 1
s_cmp_lg_u32 s26, 0
s_cbranch_scc1 L_s1l_small_loop
s_waitcnt vmcnt(16)
s_barrier
s_add_u32 m0, s28, 98304
s_nop 0
buffer_load_dwordx4 v16, s[8:11], s24 offen offset:0 lds
buffer_load_dwordx4 v17, s[8:11], s24 offen offset:1024 lds
buffer_load_dwordx4 v18, s[8:11], s24 offen offset:2048 lds
buffer_load_dwordx4 v19, s[8:11], s24 offen offset:3072 lds
s_add_u32 m0, s28, 114688
s_nop 0
buffer_load_dwordx4 v10, s[12:15], s25 offen offset:0 lds
buffer_load_dwordx4 v11, s[12:15], s25 offen offset:1024 lds
buffer_load_dwordx4 v12, s[12:15], s25 offen offset:2048 lds
buffer_load_dwordx4 v13, s[12:15], s25 offen offset:3072 lds
s_add_u32 s24, s24, 176128
s_add_u32 s25, s25, 128
s_waitcnt vmcnt(16)
s_barrier
s_waitcnt vmcnt(8)
s_barrier
s_waitcnt vmcnt(0)
s_barrier
L_s1_done:
s_endpgm
.p2align 8
.globl stage2_kernel
.type stage2_kernel,@function
stage2_kernel:
s_cmp_ge_u32 s2, 256
s_cbranch_scc1 L_s2_done
s_load_dwordx2 s[4:5], s[0:1], 88
s_load_dwordx2 s[6:7], s[0:1], 0
s_load_dwordx2 s[32:33], s[0:1], 72
v_and_b32 v1, 63, v0
v_lshrrev_b32 v2, 6, v0
s_nop 0
v_readfirstlane_b32 s3, v2
s_nop 3
s_and_b32 s40, s2, 7
s_lshr_b32 s41, s2, 6
s_lshl_b32 s41, s41, 3
s_add_u32 s40, s40, s41
s_lshr_b32 s41, s2, 3
s_and_b32 s41, s41, 7
s_waitcnt lgkmcnt(0)
s_cmp_ge_u32 s3, 4
s_cbranch_scc1 L_s2_loader
s_lshr_b32 s34, s3, 1
s_and_b32 s35, s3, 1
s_lshl_b32 s36, s34, 5
s_lshl_b32 s37, s35, 5
s_mov_b32 s20, s6
s_and_b32 s21, s7, 0xffff
s_mov_b32 s22, 2097152
s_mov_b32 s23, 0x00020000
s_mov_b32 s16, s32
s_and_b32 s17, s33, 0xffff
s_mov_b32 s18, 2097152
s_mov_b32 s19, 0x00020000
s_lshl_b32 s45, s40, 6
s_add_u32 s45, s45, s37
s_lshl_b32 s45, s45, 10
s_lshl_b32 s44, s41, 6
s_add_u32 s44, s44, s36
s_lshl_b32 s44, s44, 1
s_add_u32 s45, s45, s44
s_add_u32 s46, s45, 16384
v_lshrrev_b32 v2, 2, v1
v_lshlrev_b32 v2, 10, v2
v_and_b32 v3, 3, v1
v_lshlrev_b32 v3, 4, v3
v_add_u32 v9, v2, v3
buffer_load_dwordx4 v[160:163], v9, s[20:23], s45 offen
buffer_load_dwordx4 v[164:167], v9, s[20:23], s46 offen
v_and_b32 v2, 31, v1
v_lshrrev_b32 v3, 5, v1
v_lshrrev_b32 v4, 1, v2
v_and_b32 v4, 7, v4
v_xor_b32 v4, v4, v3
v_lshlrev_b32 v4, 4, v4
v_lshlrev_b32 v5, 7, v2
v_add_u32 v4, v4, v5
s_lshl_b32 s30, s36, 7
v_xor_b32 v5, 0, v4
v_add_u32 v16, s30, v5
v_add_u32 v20, 0x10000, v16
v_xor_b32 v5, 32, v4
v_add_u32 v17, s30, v5
v_add_u32 v21, 0x10000, v17
v_xor_b32 v5, 64, v4
v_add_u32 v18, s30, v5
v_add_u32 v22, 0x10000, v18
v_xor_b32 v5, 96, v4
v_add_u32 v19, s30, v5
v_add_u32 v23, 0x10000, v19
v_and_b32 v2, 31, v1
v_lshrrev_b32 v3, 5, v1
v_lshrrev_b32 v4, 1, v2
v_and_b32 v4, 7, v4
v_xor_b32 v4, v4, v3
v_lshlrev_b32 v4, 4, v4
v_lshlrev_b32 v5, 7, v2
v_add_u32 v4, v4, v5
s_lshl_b32 s30, s37, 7
v_xor_b32 v5, 0, v4
v_add_u32 v24, s30, v5
v_add_u32 v28, 0x10000, v24
v_xor_b32 v5, 32, v4
v_add_u32 v25, s30, v5
v_add_u32 v29, 0x10000, v25
v_xor_b32 v5, 64, v4
v_add_u32 v26, s30, v5
v_add_u32 v30, 0x10000, v26
v_xor_b32 v5, 96, v4
v_add_u32 v27, s30, v5
v_add_u32 v31, 0x10000, v27
s_lshl_b32 s49, s3, 13
s_add_u32 s49, s49, 131072
v_mov_b32 v96, 0
v_mov_b32 v97, 0
v_mov_b32 v98, 0
v_mov_b32 v99, 0
v_mov_b32 v100, 0
v_mov_b32 v101, 0
v_mov_b32 v102, 0
v_mov_b32 v103, 0
v_mov_b32 v104, 0
v_mov_b32 v105, 0
v_mov_b32 v106, 0
v_mov_b32 v107, 0
v_mov_b32 v108, 0
v_mov_b32 v109, 0
v_mov_b32 v110, 0
v_mov_b32 v111, 0
s_barrier
ds_read_b128 v[32:35], v16 offset:0
ds_read_b128 v[36:39], v24 offset:16384
ds_read_b128 v[40:43], v17 offset:0
ds_read_b128 v[44:47], v25 offset:16384
ds_read_b128 v[48:51], v18 offset:0
ds_read_b128 v[52:55], v26 offset:16384
ds_read_b128 v[56:59], v19 offset:0
ds_read_b128 v[60:63], v27 offset:16384
s_waitcnt lgkmcnt(6)
v_mfma_f32_32x32x16_bf16 v[96:111], v[32:35], v[36:39], v[96:111]
ds_read_b128 v[32:35], v16 offset:8192
ds_read_b128 v[36:39], v24 offset:24576
s_waitcnt lgkmcnt(6)
v_mfma_f32_32x32x16_bf16 v[96:111], v[40:43], v[44:47], v[96:111]
ds_read_b128 v[40:43], v17 offset:8192
ds_read_b128 v[44:47], v25 offset:24576
s_waitcnt lgkmcnt(6)
v_mfma_f32_32x32x16_bf16 v[96:111], v[48:51], v[52:55], v[96:111]
ds_read_b128 v[48:51], v18 offset:8192
ds_read_b128 v[52:55], v26 offset:24576
s_waitcnt lgkmcnt(6)
v_mfma_f32_32x32x16_bf16 v[96:111], v[56:59], v[60:63], v[96:111]
ds_read_b128 v[56:59], v19 offset:8192
ds_read_b128 v[60:63], v27 offset:24576
s_waitcnt lgkmcnt(6)
v_mfma_f32_32x32x16_bf16 v[96:111], v[32:35], v[36:39], v[96:111]
s_waitcnt lgkmcnt(0)
s_barrier
ds_read_b128 v[32:35], v16 offset:32768
ds_read_b128 v[36:39], v24 offset:49152
v_mfma_f32_32x32x16_bf16 v[96:111], v[40:43], v[44:47], v[96:111]
ds_read_b128 v[40:43], v17 offset:32768
ds_read_b128 v[44:47], v25 offset:49152
v_mfma_f32_32x32x16_bf16 v[96:111], v[48:51], v[52:55], v[96:111]
ds_read_b128 v[48:51], v18 offset:32768
ds_read_b128 v[52:55], v26 offset:49152
v_mfma_f32_32x32x16_bf16 v[96:111], v[56:59], v[60:63], v[96:111]
ds_read_b128 v[56:59], v19 offset:32768
ds_read_b128 v[60:63], v27 offset:49152
s_waitcnt lgkmcnt(6)
v_mfma_f32_32x32x16_bf16 v[96:111], v[32:35], v[36:39], v[96:111]
ds_read_b128 v[32:35], v16 offset:40960
ds_read_b128 v[36:39], v24 offset:57344
s_waitcnt lgkmcnt(6)
v_mfma_f32_32x32x16_bf16 v[96:111], v[40:43], v[44:47], v[96:111]
ds_read_b128 v[40:43], v17 offset:40960
ds_read_b128 v[44:47], v25 offset:57344
s_waitcnt lgkmcnt(6)
v_mfma_f32_32x32x16_bf16 v[96:111], v[48:51], v[52:55], v[96:111]
ds_read_b128 v[48:51], v18 offset:40960
ds_read_b128 v[52:55], v26 offset:57344
s_waitcnt lgkmcnt(6)
v_mfma_f32_32x32x16_bf16 v[96:111], v[56:59], v[60:63], v[96:111]
ds_read_b128 v[56:59], v19 offset:40960
ds_read_b128 v[60:63], v27 offset:57344
s_waitcnt lgkmcnt(6)
v_mfma_f32_32x32x16_bf16 v[96:111], v[32:35], v[36:39], v[96:111]
s_waitcnt lgkmcnt(0)
s_barrier
ds_read_b128 v[32:35], v20 offset:0
ds_read_b128 v[36:39], v28 offset:16384
v_mfma_f32_32x32x16_bf16 v[96:111], v[40:43], v[44:47], v[96:111]
ds_read_b128 v[40:43], v21 offset:0
ds_read_b128 v[44:47], v29 offset:16384
v_mfma_f32_32x32x16_bf16 v[96:111], v[48:51], v[52:55], v[96:111]
ds_read_b128 v[48:51], v22 offset:0
ds_read_b128 v[52:55], v30 offset:16384
v_mfma_f32_32x32x16_bf16 v[96:111], v[56:59], v[60:63], v[96:111]
ds_read_b128 v[56:59], v23 offset:0
ds_read_b128 v[60:63], v31 offset:16384
s_waitcnt lgkmcnt(6)
v_mfma_f32_32x32x16_bf16 v[96:111], v[32:35], v[36:39], v[96:111]
ds_read_b128 v[32:35], v20 offset:8192
ds_read_b128 v[36:39], v28 offset:24576
s_waitcnt lgkmcnt(6)
v_mfma_f32_32x32x16_bf16 v[96:111], v[40:43], v[44:47], v[96:111]
ds_read_b128 v[40:43], v21 offset:8192
ds_read_b128 v[44:47], v29 offset:24576
s_waitcnt lgkmcnt(6)
v_mfma_f32_32x32x16_bf16 v[96:111], v[48:51], v[52:55], v[96:111]
ds_read_b128 v[48:51], v22 offset:8192
ds_read_b128 v[52:55], v30 offset:24576
s_waitcnt lgkmcnt(6)
v_mfma_f32_32x32x16_bf16 v[96:111], v[56:59], v[60:63], v[96:111]
ds_read_b128 v[56:59], v23 offset:8192
ds_read_b128 v[60:63], v31 offset:24576
s_waitcnt lgkmcnt(6)
v_mfma_f32_32x32x16_bf16 v[96:111], v[32:35], v[36:39], v[96:111]
s_waitcnt lgkmcnt(0)
s_barrier
ds_read_b128 v[32:35], v20 offset:32768
ds_read_b128 v[36:39], v28 offset:49152
v_mfma_f32_32x32x16_bf16 v[96:111], v[40:43], v[44:47], v[96:111]
ds_read_b128 v[40:43], v21 offset:32768
ds_read_b128 v[44:47], v29 offset:49152
v_mfma_f32_32x32x16_bf16 v[96:111], v[48:51], v[52:55], v[96:111]
ds_read_b128 v[48:51], v22 offset:32768
ds_read_b128 v[52:55], v30 offset:49152
v_mfma_f32_32x32x16_bf16 v[96:111], v[56:59], v[60:63], v[96:111]
ds_read_b128 v[56:59], v23 offset:32768
ds_read_b128 v[60:63], v31 offset:49152
s_waitcnt lgkmcnt(6)
v_mfma_f32_32x32x16_bf16 v[96:111], v[32:35], v[36:39], v[96:111]
ds_read_b128 v[32:35], v20 offset:40960
ds_read_b128 v[36:39], v28 offset:57344
s_waitcnt lgkmcnt(6)
v_mfma_f32_32x32x16_bf16 v[96:111], v[40:43], v[44:47], v[96:111]
ds_read_b128 v[40:43], v21 offset:40960
ds_read_b128 v[44:47], v29 offset:57344
s_waitcnt lgkmcnt(6)
v_mfma_f32_32x32x16_bf16 v[96:111], v[48:51], v[52:55], v[96:111]
ds_read_b128 v[48:51], v22 offset:40960
ds_read_b128 v[52:55], v30 offset:57344
s_waitcnt lgkmcnt(6)
v_mfma_f32_32x32x16_bf16 v[96:111], v[56:59], v[60:63], v[96:111]
ds_read_b128 v[56:59], v23 offset:40960
ds_read_b128 v[60:63], v31 offset:57344
s_waitcnt lgkmcnt(6)
v_mfma_f32_32x32x16_bf16 v[96:111], v[32:35], v[36:39], v[96:111]
s_waitcnt lgkmcnt(0)
s_barrier
ds_read_b128 v[32:35], v16 offset:0
ds_read_b128 v[36:39], v24 offset:16384
v_mfma_f32_32x32x16_bf16 v[96:111], v[40:43], v[44:47], v[96:111]
ds_read_b128 v[40:43], v17 offset:0
ds_read_b128 v[44:47], v25 offset:16384
v_mfma_f32_32x32x16_bf16 v[96:111], v[48:51], v[52:55], v[96:111]
ds_read_b128 v[48:51], v18 offset:0
ds_read_b128 v[52:55], v26 offset:16384
v_mfma_f32_32x32x16_bf16 v[96:111], v[56:59], v[60:63], v[96:111]
ds_read_b128 v[56:59], v19 offset:0
ds_read_b128 v[60:63], v27 offset:16384
s_waitcnt lgkmcnt(6)
v_mfma_f32_32x32x16_bf16 v[96:111], v[32:35], v[36:39], v[96:111]
ds_read_b128 v[32:35], v16 offset:8192
ds_read_b128 v[36:39], v24 offset:24576
s_waitcnt lgkmcnt(6)
v_mfma_f32_32x32x16_bf16 v[96:111], v[40:43], v[44:47], v[96:111]
ds_read_b128 v[40:43], v17 offset:8192
ds_read_b128 v[44:47], v25 offset:24576
s_waitcnt lgkmcnt(6)
v_mfma_f32_32x32x16_bf16 v[96:111], v[48:51], v[52:55], v[96:111]
ds_read_b128 v[48:51], v18 offset:8192
ds_read_b128 v[52:55], v26 offset:24576
s_waitcnt lgkmcnt(6)
v_mfma_f32_32x32x16_bf16 v[96:111], v[56:59], v[60:63], v[96:111]
ds_read_b128 v[56:59], v19 offset:8192
ds_read_b128 v[60:63], v27 offset:24576
s_waitcnt lgkmcnt(6)
v_mfma_f32_32x32x16_bf16 v[96:111], v[32:35], v[36:39], v[96:111]
s_waitcnt lgkmcnt(0)
s_barrier
ds_read_b128 v[32:35], v16 offset:32768
ds_read_b128 v[36:39], v24 offset:49152
v_mfma_f32_32x32x16_bf16 v[96:111], v[40:43], v[44:47], v[96:111]
ds_read_b128 v[40:43], v17 offset:32768
ds_read_b128 v[44:47], v25 offset:49152
v_mfma_f32_32x32x16_bf16 v[96:111], v[48:51], v[52:55], v[96:111]
ds_read_b128 v[48:51], v18 offset:32768
ds_read_b128 v[52:55], v26 offset:49152
v_mfma_f32_32x32x16_bf16 v[96:111], v[56:59], v[60:63], v[96:111]
ds_read_b128 v[56:59], v19 offset:32768
ds_read_b128 v[60:63], v27 offset:49152
s_waitcnt lgkmcnt(6)
v_mfma_f32_32x32x16_bf16 v[96:111], v[32:35], v[36:39], v[96:111]
ds_read_b128 v[32:35], v16 offset:40960
ds_read_b128 v[36:39], v24 offset:57344
s_waitcnt lgkmcnt(6)
v_mfma_f32_32x32x16_bf16 v[96:111], v[40:43], v[44:47], v[96:111]
ds_read_b128 v[40:43], v17 offset:40960
ds_read_b128 v[44:47], v25 offset:57344
s_waitcnt lgkmcnt(6)
v_mfma_f32_32x32x16_bf16 v[96:111], v[48:51], v[52:55], v[96:111]
ds_read_b128 v[48:51], v18 offset:40960
ds_read_b128 v[52:55], v26 offset:57344
s_waitcnt lgkmcnt(6)
v_mfma_f32_32x32x16_bf16 v[96:111], v[56:59], v[60:63], v[96:111]
ds_read_b128 v[56:59], v19 offset:40960
ds_read_b128 v[60:63], v27 offset:57344
s_waitcnt lgkmcnt(6)
v_mfma_f32_32x32x16_bf16 v[96:111], v[32:35], v[36:39], v[96:111]
s_waitcnt lgkmcnt(0)
s_barrier
ds_read_b128 v[32:35], v20 offset:0
ds_read_b128 v[36:39], v28 offset:16384
v_mfma_f32_32x32x16_bf16 v[96:111], v[40:43], v[44:47], v[96:111]
ds_read_b128 v[40:43], v21 offset:0
ds_read_b128 v[44:47], v29 offset:16384
v_mfma_f32_32x32x16_bf16 v[96:111], v[48:51], v[52:55], v[96:111]
ds_read_b128 v[48:51], v22 offset:0
ds_read_b128 v[52:55], v30 offset:16384
v_mfma_f32_32x32x16_bf16 v[96:111], v[56:59], v[60:63], v[96:111]
ds_read_b128 v[56:59], v23 offset:0
ds_read_b128 v[60:63], v31 offset:16384
s_waitcnt lgkmcnt(6)
v_mfma_f32_32x32x16_bf16 v[96:111], v[32:35], v[36:39], v[96:111]
ds_read_b128 v[32:35], v20 offset:8192
ds_read_b128 v[36:39], v28 offset:24576
s_waitcnt lgkmcnt(6)
v_mfma_f32_32x32x16_bf16 v[96:111], v[40:43], v[44:47], v[96:111]
ds_read_b128 v[40:43], v21 offset:8192
ds_read_b128 v[44:47], v29 offset:24576
s_waitcnt lgkmcnt(6)
v_mfma_f32_32x32x16_bf16 v[96:111], v[48:51], v[52:55], v[96:111]
ds_read_b128 v[48:51], v22 offset:8192
ds_read_b128 v[52:55], v30 offset:24576
s_waitcnt lgkmcnt(6)
v_mfma_f32_32x32x16_bf16 v[96:111], v[56:59], v[60:63], v[96:111]
ds_read_b128 v[56:59], v23 offset:8192
ds_read_b128 v[60:63], v31 offset:24576
s_waitcnt lgkmcnt(6)
v_mfma_f32_32x32x16_bf16 v[96:111], v[32:35], v[36:39], v[96:111]
s_waitcnt lgkmcnt(0)
s_barrier
ds_read_b128 v[32:35], v20 offset:32768
ds_read_b128 v[36:39], v28 offset:49152
v_mfma_f32_32x32x16_bf16 v[96:111], v[40:43], v[44:47], v[96:111]
ds_read_b128 v[40:43], v21 offset:32768
ds_read_b128 v[44:47], v29 offset:49152
v_mfma_f32_32x32x16_bf16 v[96:111], v[48:51], v[52:55], v[96:111]
ds_read_b128 v[48:51], v22 offset:32768
ds_read_b128 v[52:55], v30 offset:49152
v_mfma_f32_32x32x16_bf16 v[96:111], v[56:59], v[60:63], v[96:111]
ds_read_b128 v[56:59], v23 offset:32768
ds_read_b128 v[60:63], v31 offset:49152
s_waitcnt lgkmcnt(6)
v_mfma_f32_32x32x16_bf16 v[96:111], v[32:35], v[36:39], v[96:111]
ds_read_b128 v[32:35], v20 offset:40960
ds_read_b128 v[36:39], v28 offset:57344
s_waitcnt lgkmcnt(6)
v_mfma_f32_32x32x16_bf16 v[96:111], v[40:43], v[44:47], v[96:111]
ds_read_b128 v[40:43], v21 offset:40960
ds_read_b128 v[44:47], v29 offset:57344
s_waitcnt lgkmcnt(6)
v_mfma_f32_32x32x16_bf16 v[96:111], v[48:51], v[52:55], v[96:111]
ds_read_b128 v[48:51], v22 offset:40960
ds_read_b128 v[52:55], v30 offset:57344
s_waitcnt lgkmcnt(6)
v_mfma_f32_32x32x16_bf16 v[96:111], v[56:59], v[60:63], v[96:111]
ds_read_b128 v[56:59], v23 offset:40960
ds_read_b128 v[60:63], v31 offset:57344
s_waitcnt lgkmcnt(6)
v_mfma_f32_32x32x16_bf16 v[96:111], v[32:35], v[36:39], v[96:111]
s_waitcnt lgkmcnt(0)
s_barrier
ds_read_b128 v[32:35], v16 offset:0
ds_read_b128 v[36:39], v24 offset:16384
v_mfma_f32_32x32x16_bf16 v[96:111], v[40:43], v[44:47], v[96:111]
ds_read_b128 v[40:43], v17 offset:0
ds_read_b128 v[44:47], v25 offset:16384
v_mfma_f32_32x32x16_bf16 v[96:111], v[48:51], v[52:55], v[96:111]
ds_read_b128 v[48:51], v18 offset:0
ds_read_b128 v[52:55], v26 offset:16384
v_mfma_f32_32x32x16_bf16 v[96:111], v[56:59], v[60:63], v[96:111]
ds_read_b128 v[56:59], v19 offset:0
ds_read_b128 v[60:63], v27 offset:16384
s_waitcnt lgkmcnt(6)
v_mfma_f32_32x32x16_bf16 v[96:111], v[32:35], v[36:39], v[96:111]
ds_read_b128 v[32:35], v16 offset:8192
ds_read_b128 v[36:39], v24 offset:24576
s_waitcnt lgkmcnt(6)
v_mfma_f32_32x32x16_bf16 v[96:111], v[40:43], v[44:47], v[96:111]
ds_read_b128 v[40:43], v17 offset:8192
ds_read_b128 v[44:47], v25 offset:24576
s_waitcnt lgkmcnt(6)
v_mfma_f32_32x32x16_bf16 v[96:111], v[48:51], v[52:55], v[96:111]
ds_read_b128 v[48:51], v18 offset:8192
ds_read_b128 v[52:55], v26 offset:24576
s_waitcnt lgkmcnt(6)
v_mfma_f32_32x32x16_bf16 v[96:111], v[56:59], v[60:63], v[96:111]
ds_read_b128 v[56:59], v19 offset:8192
ds_read_b128 v[60:63], v27 offset:24576
s_waitcnt lgkmcnt(6)
v_mfma_f32_32x32x16_bf16 v[96:111], v[32:35], v[36:39], v[96:111]
s_waitcnt lgkmcnt(0)
s_barrier
ds_read_b128 v[32:35], v16 offset:32768
ds_read_b128 v[36:39], v24 offset:49152
v_mfma_f32_32x32x16_bf16 v[96:111], v[40:43], v[44:47], v[96:111]
ds_read_b128 v[40:43], v17 offset:32768
ds_read_b128 v[44:47], v25 offset:49152
v_mfma_f32_32x32x16_bf16 v[96:111], v[48:51], v[52:55], v[96:111]
ds_read_b128 v[48:51], v18 offset:32768
ds_read_b128 v[52:55], v26 offset:49152
v_mfma_f32_32x32x16_bf16 v[96:111], v[56:59], v[60:63], v[96:111]
ds_read_b128 v[56:59], v19 offset:32768
ds_read_b128 v[60:63], v27 offset:49152
s_waitcnt lgkmcnt(6)
v_mfma_f32_32x32x16_bf16 v[96:111], v[32:35], v[36:39], v[96:111]
ds_read_b128 v[32:35], v16 offset:40960
ds_read_b128 v[36:39], v24 offset:57344
s_waitcnt lgkmcnt(6)
v_mfma_f32_32x32x16_bf16 v[96:111], v[40:43], v[44:47], v[96:111]
ds_read_b128 v[40:43], v17 offset:40960
ds_read_b128 v[44:47], v25 offset:57344
s_waitcnt lgkmcnt(6)
v_mfma_f32_32x32x16_bf16 v[96:111], v[48:51], v[52:55], v[96:111]
ds_read_b128 v[48:51], v18 offset:40960
ds_read_b128 v[52:55], v26 offset:57344
s_waitcnt lgkmcnt(6)
v_mfma_f32_32x32x16_bf16 v[96:111], v[56:59], v[60:63], v[96:111]
ds_read_b128 v[56:59], v19 offset:40960
ds_read_b128 v[60:63], v27 offset:57344
s_waitcnt lgkmcnt(6)
v_mfma_f32_32x32x16_bf16 v[96:111], v[32:35], v[36:39], v[96:111]
s_waitcnt lgkmcnt(0)
s_barrier
ds_read_b128 v[32:35], v20 offset:0
ds_read_b128 v[36:39], v28 offset:16384
v_mfma_f32_32x32x16_bf16 v[96:111], v[40:43], v[44:47], v[96:111]
ds_read_b128 v[40:43], v21 offset:0
ds_read_b128 v[44:47], v29 offset:16384
v_mfma_f32_32x32x16_bf16 v[96:111], v[48:51], v[52:55], v[96:111]
ds_read_b128 v[48:51], v22 offset:0
ds_read_b128 v[52:55], v30 offset:16384
v_mfma_f32_32x32x16_bf16 v[96:111], v[56:59], v[60:63], v[96:111]
ds_read_b128 v[56:59], v23 offset:0
ds_read_b128 v[60:63], v31 offset:16384
s_waitcnt lgkmcnt(6)
v_mfma_f32_32x32x16_bf16 v[96:111], v[32:35], v[36:39], v[96:111]
ds_read_b128 v[32:35], v20 offset:8192
ds_read_b128 v[36:39], v28 offset:24576
s_waitcnt lgkmcnt(6)
v_mfma_f32_32x32x16_bf16 v[96:111], v[40:43], v[44:47], v[96:111]
ds_read_b128 v[40:43], v21 offset:8192
ds_read_b128 v[44:47], v29 offset:24576
s_waitcnt lgkmcnt(6)
v_mfma_f32_32x32x16_bf16 v[96:111], v[48:51], v[52:55], v[96:111]
ds_read_b128 v[48:51], v22 offset:8192
ds_read_b128 v[52:55], v30 offset:24576
s_waitcnt lgkmcnt(6)
v_mfma_f32_32x32x16_bf16 v[96:111], v[56:59], v[60:63], v[96:111]
ds_read_b128 v[56:59], v23 offset:8192
ds_read_b128 v[60:63], v31 offset:24576
s_waitcnt lgkmcnt(6)
v_mfma_f32_32x32x16_bf16 v[96:111], v[32:35], v[36:39], v[96:111]
s_waitcnt lgkmcnt(0)
s_barrier
ds_read_b128 v[32:35], v20 offset:32768
ds_read_b128 v[36:39], v28 offset:49152
v_mfma_f32_32x32x16_bf16 v[96:111], v[40:43], v[44:47], v[96:111]
ds_read_b128 v[40:43], v21 offset:32768
ds_read_b128 v[44:47], v29 offset:49152
v_mfma_f32_32x32x16_bf16 v[96:111], v[48:51], v[52:55], v[96:111]
ds_read_b128 v[48:51], v22 offset:32768
ds_read_b128 v[52:55], v30 offset:49152
v_mfma_f32_32x32x16_bf16 v[96:111], v[56:59], v[60:63], v[96:111]
ds_read_b128 v[56:59], v23 offset:32768
ds_read_b128 v[60:63], v31 offset:49152
s_waitcnt lgkmcnt(6)
v_mfma_f32_32x32x16_bf16 v[96:111], v[32:35], v[36:39], v[96:111]
ds_read_b128 v[32:35], v20 offset:40960
ds_read_b128 v[36:39], v28 offset:57344
s_waitcnt lgkmcnt(6)
v_mfma_f32_32x32x16_bf16 v[96:111], v[40:43], v[44:47], v[96:111]
ds_read_b128 v[40:43], v21 offset:40960
ds_read_b128 v[44:47], v29 offset:57344
s_waitcnt lgkmcnt(6)
v_mfma_f32_32x32x16_bf16 v[96:111], v[48:51], v[52:55], v[96:111]
ds_read_b128 v[48:51], v22 offset:40960
ds_read_b128 v[52:55], v30 offset:57344
s_waitcnt lgkmcnt(6)
v_mfma_f32_32x32x16_bf16 v[96:111], v[56:59], v[60:63], v[96:111]
ds_read_b128 v[56:59], v23 offset:40960
ds_read_b128 v[60:63], v31 offset:57344
s_waitcnt lgkmcnt(6)
v_mfma_f32_32x32x16_bf16 v[96:111], v[32:35], v[36:39], v[96:111]
s_waitcnt lgkmcnt(0)
s_barrier
ds_read_b128 v[32:35], v16 offset:0
ds_read_b128 v[36:39], v24 offset:16384
v_mfma_f32_32x32x16_bf16 v[96:111], v[40:43], v[44:47], v[96:111]
ds_read_b128 v[40:43], v17 offset:0
ds_read_b128 v[44:47], v25 offset:16384
v_mfma_f32_32x32x16_bf16 v[96:111], v[48:51], v[52:55], v[96:111]
ds_read_b128 v[48:51], v18 offset:0
ds_read_b128 v[52:55], v26 offset:16384
v_mfma_f32_32x32x16_bf16 v[96:111], v[56:59], v[60:63], v[96:111]
ds_read_b128 v[56:59], v19 offset:0
ds_read_b128 v[60:63], v27 offset:16384
s_waitcnt lgkmcnt(6)
v_mfma_f32_32x32x16_bf16 v[96:111], v[32:35], v[36:39], v[96:111]
ds_read_b128 v[32:35], v16 offset:8192
ds_read_b128 v[36:39], v24 offset:24576
s_waitcnt lgkmcnt(6)
v_mfma_f32_32x32x16_bf16 v[96:111], v[40:43], v[44:47], v[96:111]
ds_read_b128 v[40:43], v17 offset:8192
ds_read_b128 v[44:47], v25 offset:24576
s_waitcnt lgkmcnt(6)
v_mfma_f32_32x32x16_bf16 v[96:111], v[48:51], v[52:55], v[96:111]
ds_read_b128 v[48:51], v18 offset:8192
ds_read_b128 v[52:55], v26 offset:24576
s_waitcnt lgkmcnt(6)
v_mfma_f32_32x32x16_bf16 v[96:111], v[56:59], v[60:63], v[96:111]
ds_read_b128 v[56:59], v19 offset:8192
ds_read_b128 v[60:63], v27 offset:24576
s_waitcnt lgkmcnt(6)
v_mfma_f32_32x32x16_bf16 v[96:111], v[32:35], v[36:39], v[96:111]
s_waitcnt lgkmcnt(0)
s_barrier
ds_read_b128 v[32:35], v16 offset:32768
ds_read_b128 v[36:39], v24 offset:49152
v_mfma_f32_32x32x16_bf16 v[96:111], v[40:43], v[44:47], v[96:111]
ds_read_b128 v[40:43], v17 offset:32768
ds_read_b128 v[44:47], v25 offset:49152
v_mfma_f32_32x32x16_bf16 v[96:111], v[48:51], v[52:55], v[96:111]
ds_read_b128 v[48:51], v18 offset:32768
ds_read_b128 v[52:55], v26 offset:49152
v_mfma_f32_32x32x16_bf16 v[96:111], v[56:59], v[60:63], v[96:111]
ds_read_b128 v[56:59], v19 offset:32768
ds_read_b128 v[60:63], v27 offset:49152
s_waitcnt lgkmcnt(6)
v_mfma_f32_32x32x16_bf16 v[96:111], v[32:35], v[36:39], v[96:111]
ds_read_b128 v[32:35], v16 offset:40960
ds_read_b128 v[36:39], v24 offset:57344
s_waitcnt lgkmcnt(6)
v_mfma_f32_32x32x16_bf16 v[96:111], v[40:43], v[44:47], v[96:111]
ds_read_b128 v[40:43], v17 offset:40960
ds_read_b128 v[44:47], v25 offset:57344
s_waitcnt lgkmcnt(6)
v_mfma_f32_32x32x16_bf16 v[96:111], v[48:51], v[52:55], v[96:111]
ds_read_b128 v[48:51], v18 offset:40960
ds_read_b128 v[52:55], v26 offset:57344
s_waitcnt lgkmcnt(6)
v_mfma_f32_32x32x16_bf16 v[96:111], v[56:59], v[60:63], v[96:111]
ds_read_b128 v[56:59], v19 offset:40960
ds_read_b128 v[60:63], v27 offset:57344
s_waitcnt lgkmcnt(6)
v_mfma_f32_32x32x16_bf16 v[96:111], v[32:35], v[36:39], v[96:111]
s_waitcnt lgkmcnt(0)
s_barrier
ds_read_b128 v[32:35], v20 offset:0
ds_read_b128 v[36:39], v28 offset:16384
v_mfma_f32_32x32x16_bf16 v[96:111], v[40:43], v[44:47], v[96:111]
ds_read_b128 v[40:43], v21 offset:0
ds_read_b128 v[44:47], v29 offset:16384
v_mfma_f32_32x32x16_bf16 v[96:111], v[48:51], v[52:55], v[96:111]
ds_read_b128 v[48:51], v22 offset:0
ds_read_b128 v[52:55], v30 offset:16384
v_mfma_f32_32x32x16_bf16 v[96:111], v[56:59], v[60:63], v[96:111]
ds_read_b128 v[56:59], v23 offset:0
ds_read_b128 v[60:63], v31 offset:16384
s_waitcnt lgkmcnt(6)
v_mfma_f32_32x32x16_bf16 v[96:111], v[32:35], v[36:39], v[96:111]
ds_read_b128 v[32:35], v20 offset:8192
ds_read_b128 v[36:39], v28 offset:24576
s_waitcnt lgkmcnt(6)
v_mfma_f32_32x32x16_bf16 v[96:111], v[40:43], v[44:47], v[96:111]
ds_read_b128 v[40:43], v21 offset:8192
ds_read_b128 v[44:47], v29 offset:24576
s_waitcnt lgkmcnt(6)
v_mfma_f32_32x32x16_bf16 v[96:111], v[48:51], v[52:55], v[96:111]
ds_read_b128 v[48:51], v22 offset:8192
ds_read_b128 v[52:55], v30 offset:24576
s_waitcnt lgkmcnt(6)
v_mfma_f32_32x32x16_bf16 v[96:111], v[56:59], v[60:63], v[96:111]
ds_read_b128 v[56:59], v23 offset:8192
ds_read_b128 v[60:63], v31 offset:24576
s_waitcnt lgkmcnt(6)
v_mfma_f32_32x32x16_bf16 v[96:111], v[32:35], v[36:39], v[96:111]
s_waitcnt lgkmcnt(0)
s_barrier
ds_read_b128 v[32:35], v20 offset:32768
ds_read_b128 v[36:39], v28 offset:49152
v_mfma_f32_32x32x16_bf16 v[96:111], v[40:43], v[44:47], v[96:111]
ds_read_b128 v[40:43], v21 offset:32768
ds_read_b128 v[44:47], v29 offset:49152
v_mfma_f32_32x32x16_bf16 v[96:111], v[48:51], v[52:55], v[96:111]
ds_read_b128 v[48:51], v22 offset:32768
ds_read_b128 v[52:55], v30 offset:49152
v_mfma_f32_32x32x16_bf16 v[96:111], v[56:59], v[60:63], v[96:111]
ds_read_b128 v[56:59], v23 offset:32768
ds_read_b128 v[60:63], v31 offset:49152
s_waitcnt lgkmcnt(6)
v_mfma_f32_32x32x16_bf16 v[96:111], v[32:35], v[36:39], v[96:111]
ds_read_b128 v[32:35], v20 offset:40960
ds_read_b128 v[36:39], v28 offset:57344
s_waitcnt lgkmcnt(6)
v_mfma_f32_32x32x16_bf16 v[96:111], v[40:43], v[44:47], v[96:111]
ds_read_b128 v[40:43], v21 offset:40960
ds_read_b128 v[44:47], v29 offset:57344
s_waitcnt lgkmcnt(6)
v_mfma_f32_32x32x16_bf16 v[96:111], v[48:51], v[52:55], v[96:111]
ds_read_b128 v[48:51], v22 offset:40960
ds_read_b128 v[52:55], v30 offset:57344
s_waitcnt lgkmcnt(6)
v_mfma_f32_32x32x16_bf16 v[96:111], v[56:59], v[60:63], v[96:111]
ds_read_b128 v[56:59], v23 offset:40960
ds_read_b128 v[60:63], v31 offset:57344
s_waitcnt lgkmcnt(6)
v_mfma_f32_32x32x16_bf16 v[96:111], v[32:35], v[36:39], v[96:111]
s_waitcnt lgkmcnt(0)
s_barrier
ds_read_b128 v[32:35], v16 offset:0
ds_read_b128 v[36:39], v24 offset:16384
v_mfma_f32_32x32x16_bf16 v[96:111], v[40:43], v[44:47], v[96:111]
ds_read_b128 v[40:43], v17 offset:0
ds_read_b128 v[44:47], v25 offset:16384
v_mfma_f32_32x32x16_bf16 v[96:111], v[48:51], v[52:55], v[96:111]
ds_read_b128 v[48:51], v18 offset:0
ds_read_b128 v[52:55], v26 offset:16384
v_mfma_f32_32x32x16_bf16 v[96:111], v[56:59], v[60:63], v[96:111]
ds_read_b128 v[56:59], v19 offset:0
ds_read_b128 v[60:63], v27 offset:16384
s_waitcnt lgkmcnt(6)
v_mfma_f32_32x32x16_bf16 v[96:111], v[32:35], v[36:39], v[96:111]
ds_read_b128 v[32:35], v16 offset:8192
ds_read_b128 v[36:39], v24 offset:24576
s_waitcnt lgkmcnt(6)
v_mfma_f32_32x32x16_bf16 v[96:111], v[40:43], v[44:47], v[96:111]
ds_read_b128 v[40:43], v17 offset:8192
ds_read_b128 v[44:47], v25 offset:24576
s_waitcnt lgkmcnt(6)
v_mfma_f32_32x32x16_bf16 v[96:111], v[48:51], v[52:55], v[96:111]
ds_read_b128 v[48:51], v18 offset:8192
ds_read_b128 v[52:55], v26 offset:24576
s_waitcnt lgkmcnt(6)
v_mfma_f32_32x32x16_bf16 v[96:111], v[56:59], v[60:63], v[96:111]
ds_read_b128 v[56:59], v19 offset:8192
ds_read_b128 v[60:63], v27 offset:24576
s_waitcnt lgkmcnt(6)
v_mfma_f32_32x32x16_bf16 v[96:111], v[32:35], v[36:39], v[96:111]
s_waitcnt lgkmcnt(0)
s_barrier
ds_read_b128 v[32:35], v16 offset:32768
ds_read_b128 v[36:39], v24 offset:49152
v_mfma_f32_32x32x16_bf16 v[96:111], v[40:43], v[44:47], v[96:111]
ds_read_b128 v[40:43], v17 offset:32768
ds_read_b128 v[44:47], v25 offset:49152
v_mfma_f32_32x32x16_bf16 v[96:111], v[48:51], v[52:55], v[96:111]
ds_read_b128 v[48:51], v18 offset:32768
ds_read_b128 v[52:55], v26 offset:49152
v_mfma_f32_32x32x16_bf16 v[96:111], v[56:59], v[60:63], v[96:111]
ds_read_b128 v[56:59], v19 offset:32768
ds_read_b128 v[60:63], v27 offset:49152
s_waitcnt lgkmcnt(6)
v_mfma_f32_32x32x16_bf16 v[96:111], v[32:35], v[36:39], v[96:111]
ds_read_b128 v[32:35], v16 offset:40960
ds_read_b128 v[36:39], v24 offset:57344
s_waitcnt lgkmcnt(6)
v_mfma_f32_32x32x16_bf16 v[96:111], v[40:43], v[44:47], v[96:111]
ds_read_b128 v[40:43], v17 offset:40960
ds_read_b128 v[44:47], v25 offset:57344
s_waitcnt lgkmcnt(6)
v_mfma_f32_32x32x16_bf16 v[96:111], v[48:51], v[52:55], v[96:111]
ds_read_b128 v[48:51], v18 offset:40960
ds_read_b128 v[52:55], v26 offset:57344
s_waitcnt lgkmcnt(6)
v_mfma_f32_32x32x16_bf16 v[96:111], v[56:59], v[60:63], v[96:111]
ds_read_b128 v[56:59], v19 offset:40960
ds_read_b128 v[60:63], v27 offset:57344
s_waitcnt lgkmcnt(6)
v_mfma_f32_32x32x16_bf16 v[96:111], v[32:35], v[36:39], v[96:111]
s_waitcnt lgkmcnt(0)
s_barrier
ds_read_b128 v[32:35], v20 offset:0
ds_read_b128 v[36:39], v28 offset:16384
v_mfma_f32_32x32x16_bf16 v[96:111], v[40:43], v[44:47], v[96:111]
ds_read_b128 v[40:43], v21 offset:0
ds_read_b128 v[44:47], v29 offset:16384
v_mfma_f32_32x32x16_bf16 v[96:111], v[48:51], v[52:55], v[96:111]
ds_read_b128 v[48:51], v22 offset:0
ds_read_b128 v[52:55], v30 offset:16384
v_mfma_f32_32x32x16_bf16 v[96:111], v[56:59], v[60:63], v[96:111]
ds_read_b128 v[56:59], v23 offset:0
ds_read_b128 v[60:63], v31 offset:16384
s_waitcnt lgkmcnt(6)
v_mfma_f32_32x32x16_bf16 v[96:111], v[32:35], v[36:39], v[96:111]
ds_read_b128 v[32:35], v20 offset:8192
ds_read_b128 v[36:39], v28 offset:24576
s_waitcnt lgkmcnt(6)
v_mfma_f32_32x32x16_bf16 v[96:111], v[40:43], v[44:47], v[96:111]
ds_read_b128 v[40:43], v21 offset:8192
ds_read_b128 v[44:47], v29 offset:24576
s_waitcnt lgkmcnt(6)
v_mfma_f32_32x32x16_bf16 v[96:111], v[48:51], v[52:55], v[96:111]
ds_read_b128 v[48:51], v22 offset:8192
ds_read_b128 v[52:55], v30 offset:24576
s_waitcnt lgkmcnt(6)
v_mfma_f32_32x32x16_bf16 v[96:111], v[56:59], v[60:63], v[96:111]
ds_read_b128 v[56:59], v23 offset:8192
ds_read_b128 v[60:63], v31 offset:24576
s_waitcnt lgkmcnt(6)
v_mfma_f32_32x32x16_bf16 v[96:111], v[32:35], v[36:39], v[96:111]
s_waitcnt lgkmcnt(0)
v_mfma_f32_32x32x16_bf16 v[96:111], v[40:43], v[44:47], v[96:111]
v_mfma_f32_32x32x16_bf16 v[96:111], v[48:51], v[52:55], v[96:111]
v_mfma_f32_32x32x16_bf16 v[96:111], v[56:59], v[60:63], v[96:111]
s_nop 15
v_and_b32 v2, 31, v1
v_lshrrev_b32 v3, 1, v2
v_and_b32 v3, 7, v3
v_lshrrev_b32 v4, 5, v1
v_xor_b32 v3, v3, v4
v_lshlrev_b32 v3, 4, v3
v_lshlrev_b32 v2, 7, v2
v_add_u32 v2, v2, v3
v_add_u32 v2, s49, v2
v_xor_b32 v4, 0, v2
ds_write_b128 v4, v[96:99]
v_xor_b32 v4, 32, v2
ds_write_b128 v4, v[100:103]
v_xor_b32 v4, 64, v2
ds_write_b128 v4, v[104:107]
v_xor_b32 v4, 96, v2
ds_write_b128 v4, v[108:111]
v_lshrrev_b32 v2, 2, v1
v_and_b32 v3, 3, v1
v_lshlrev_b32 v3, 1, v3
v_lshrrev_b32 v4, 3, v1
v_xor_b32 v3, v3, v4
v_lshlrev_b32 v3, 4, v3
v_lshlrev_b32 v2, 7, v2
v_add_u32 v2, v2, v3
v_add_u32 v2, s49, v2
v_xor_b32 v3, 16, v2
s_waitcnt lgkmcnt(0)
ds_read_b128 v[168:171], v2 offset:0
ds_read_b128 v[172:175], v3 offset:0
ds_read_b128 v[176:179], v2 offset:2048
ds_read_b128 v[180:183], v3 offset:2048
s_waitcnt vmcnt(0) lgkmcnt(0)
v_lshlrev_b32 v4, 16, v160
v_and_b32 v5, 0xffff0000, v160
v_add_f32 v4, v4, v168
v_add_f32 v5, v5, v169
v_cvt_pk_bf16_f32 v160, v4, v5
v_lshlrev_b32 v4, 16, v161
v_and_b32 v5, 0xffff0000, v161
v_add_f32 v4, v4, v170
v_add_f32 v5, v5, v171
v_cvt_pk_bf16_f32 v161, v4, v5
v_lshlrev_b32 v4, 16, v162
v_and_b32 v5, 0xffff0000, v162
v_add_f32 v4, v4, v172
v_add_f32 v5, v5, v173
v_cvt_pk_bf16_f32 v162, v4, v5
v_lshlrev_b32 v4, 16, v163
v_and_b32 v5, 0xffff0000, v163
v_add_f32 v4, v4, v174
v_add_f32 v5, v5, v175
v_cvt_pk_bf16_f32 v163, v4, v5
buffer_store_dwordx4 v[160:163], v9, s[16:19], s45 offen
v_lshlrev_b32 v4, 16, v164
v_and_b32 v5, 0xffff0000, v164
v_add_f32 v4, v4, v176
v_add_f32 v5, v5, v177
v_cvt_pk_bf16_f32 v164, v4, v5
v_lshlrev_b32 v4, 16, v165
v_and_b32 v5, 0xffff0000, v165
v_add_f32 v4, v4, v178
v_add_f32 v5, v5, v179
v_cvt_pk_bf16_f32 v165, v4, v5
v_lshlrev_b32 v4, 16, v166
v_and_b32 v5, 0xffff0000, v166
v_add_f32 v4, v4, v180
v_add_f32 v5, v5, v181
v_cvt_pk_bf16_f32 v166, v4, v5
v_lshlrev_b32 v4, 16, v167
v_and_b32 v5, 0xffff0000, v167
v_add_f32 v4, v4, v182
v_add_f32 v5, v5, v183
v_cvt_pk_bf16_f32 v167, v4, v5
buffer_store_dwordx4 v[164:167], v9, s[16:19], s46 offen
s_endpgm
L_s2_loader:
s_sub_u32 s3, s3, 4
s_lshr_b32 s34, s3, 1
s_and_b32 s35, s3, 1
s_lshl_b32 s28, s3, 13
s_mul_i32 s42, s41, 311296
s_add_u32 s42, s42, 2097152
s_sub_u32 s46, 4587520, s42
s_mul_i32 s43, s40, 311296
s_add_u32 s43, s43, 5242880
s_sub_u32 s47, 15204352, s43
s_cmp_eq_u32 s34, 1
s_cselect_b32 s42, s43, s42
s_cselect_b32 s46, s47, s46
s_add_u32 s38, s4, s42
s_addc_u32 s39, s5, 0
s_mov_b32 s8, s38
s_and_b32 s9, s39, 0xffff
s_mov_b32 s10, s46
s_mov_b32 s11, 0x00020000
s_lshl_b32 s24, s35, 7
s_add_u32 s25, s24, 155648
v_lshrrev_b32 v2, 3, v1
v_lshrrev_b32 v3, 4, v1
v_and_b32 v4, 7, v1
s_movk_i32 s29, 4864
v_add_u32 v5, 0, v2
v_mul_lo_u32 v5, v5, s29
v_add_u32 v6, 0, v3
v_and_b32 v6, 7, v6
v_xor_b32 v6, v6, v4
v_lshlrev_b32 v6, 4, v6
v_add_u32 v5, v5, v6
v_mov_b32 v10, v5
v_add_u32 v5, 8, v2
v_mul_lo_u32 v5, v5, s29
v_add_u32 v6, 4, v3
v_and_b32 v6, 7, v6
v_xor_b32 v6, v6, v4
v_lshlrev_b32 v6, 4, v6
v_add_u32 v5, v5, v6
v_subrev_u32 v5, 1024, v5
v_mov_b32 v11, v5
v_add_u32 v5, 16, v2
v_mul_lo_u32 v5, v5, s29
v_add_u32 v6, 8, v3
v_and_b32 v6, 7, v6
v_xor_b32 v6, v6, v4
v_lshlrev_b32 v6, 4, v6
v_add_u32 v5, v5, v6
v_subrev_u32 v5, 2048, v5
v_mov_b32 v12, v5
v_add_u32 v5, 24, v2
v_mul_lo_u32 v5, v5, s29
v_add_u32 v6, 12, v3
v_and_b32 v6, 7, v6
v_xor_b32 v6, v6, v4
v_lshlrev_b32 v6, 4, v6
v_add_u32 v5, v5, v6
v_subrev_u32 v5, 3072, v5
v_mov_b32 v13, v5
s_add_u32 m0, s28, 0
s_nop 0
buffer_load_dwordx4 v10, s[8:11], s24 offen offset:0 lds
buffer_load_dwordx4 v11, s[8:11], s24 offen offset:1024 lds
buffer_load_dwordx4 v12, s[8:11], s24 offen offset:2048 lds
buffer_load_dwordx4 v13, s[8:11], s24 offen offset:3072 lds
s_add_u32 m0, s28, 4096
s_nop 0
buffer_load_dwordx4 v10, s[8:11], s25 offen offset:0 lds
buffer_load_dwordx4 v11, s[8:11], s25 offen offset:1024 lds
buffer_load_dwordx4 v12, s[8:11], s25 offen offset:2048 lds
buffer_load_dwordx4 v13, s[8:11], s25 offen offset:3072 lds
s_add_u32 s24, s24, 256
s_add_u32 s25, s25, 256
s_add_u32 m0, s28, 32768
s_nop 0
buffer_load_dwordx4 v10, s[8:11], s24 offen offset:0 lds
buffer_load_dwordx4 v11, s[8:11], s24 offen offset:1024 lds
buffer_load_dwordx4 v12, s[8:11], s24 offen offset:2048 lds
buffer_load_dwordx4 v13, s[8:11], s24 offen offset:3072 lds
s_add_u32 m0, s28, 36864
s_nop 0
buffer_load_dwordx4 v10, s[8:11], s25 offen offset:0 lds
buffer_load_dwordx4 v11, s[8:11], s25 offen offset:1024 lds
buffer_load_dwordx4 v12, s[8:11], s25 offen offset:2048 lds
buffer_load_dwordx4 v13, s[8:11], s25 offen offset:3072 lds
s_add_u32 s24, s24, 256
s_add_u32 s25, s25, 256
s_add_u32 m0, s28, 65536
s_nop 0
buffer_load_dwordx4 v10, s[8:11], s24 offen offset:0 lds
buffer_load_dwordx4 v11, s[8:11], s24 offen offset:1024 lds
buffer_load_dwordx4 v12, s[8:11], s24 offen offset:2048 lds
buffer_load_dwordx4 v13, s[8:11], s24 offen offset:3072 lds
s_add_u32 m0, s28, 69632
s_nop 0
buffer_load_dwordx4 v10, s[8:11], s25 offen offset:0 lds
buffer_load_dwordx4 v11, s[8:11], s25 offen offset:1024 lds
buffer_load_dwordx4 v12, s[8:11], s25 offen offset:2048 lds
buffer_load_dwordx4 v13, s[8:11], s25 offen offset:3072 lds
s_add_u32 s24, s24, 256
s_add_u32 s25, s25, 256
s_waitcnt vmcnt(16)
s_barrier
s_add_u32 m0, s28, 98304
s_nop 0
buffer_load_dwordx4 v10, s[8:11], s24 offen offset:0 lds
buffer_load_dwordx4 v11, s[8:11], s24 offen offset:1024 lds
buffer_load_dwordx4 v12, s[8:11], s24 offen offset:2048 lds
buffer_load_dwordx4 v13, s[8:11], s24 offen offset:3072 lds
s_add_u32 m0, s28, 102400
s_nop 0
buffer_load_dwordx4 v10, s[8:11], s25 offen offset:0 lds
buffer_load_dwordx4 v11, s[8:11], s25 offen offset:1024 lds
buffer_load_dwordx4 v12, s[8:11], s25 offen offset:2048 lds
buffer_load_dwordx4 v13, s[8:11], s25 offen offset:3072 lds
s_add_u32 s24, s24, 256
s_add_u32 s25, s25, 256
s_waitcnt vmcnt(16)
s_barrier
s_add_u32 m0, s28, 0
s_nop 0
buffer_load_dwordx4 v10, s[8:11], s24 offen offset:0 lds
buffer_load_dwordx4 v11, s[8:11], s24 offen offset:1024 lds
buffer_load_dwordx4 v12, s[8:11], s24 offen offset:2048 lds
buffer_load_dwordx4 v13, s[8:11], s24 offen offset:3072 lds
s_add_u32 m0, s28, 4096
s_nop 0
buffer_load_dwordx4 v10, s[8:11], s25 offen offset:0 lds
buffer_load_dwordx4 v11, s[8:11], s25 offen offset:1024 lds
buffer_load_dwordx4 v12, s[8:11], s25 offen offset:2048 lds
buffer_load_dwordx4 v13, s[8:11], s25 offen offset:3072 lds
s_add_u32 s24, s24, 256
s_add_u32 s25, s25, 256
s_waitcnt vmcnt(16)
s_barrier
s_add_u32 m0, s28, 32768
s_nop 0
buffer_load_dwordx4 v10, s[8:11], s24 offen offset:0 lds
buffer_load_dwordx4 v11, s[8:11], s24 offen offset:1024 lds
buffer_load_dwordx4 v12, s[8:11], s24 offen offset:2048 lds
buffer_load_dwordx4 v13, s[8:11], s24 offen offset:3072 lds
s_add_u32 m0, s28, 36864
s_nop 0
buffer_load_dwordx4 v10, s[8:11], s25 offen offset:0 lds
buffer_load_dwordx4 v11, s[8:11], s25 offen offset:1024 lds
buffer_load_dwordx4 v12, s[8:11], s25 offen offset:2048 lds
buffer_load_dwordx4 v13, s[8:11], s25 offen offset:3072 lds
s_add_u32 s24, s24, 256
s_add_u32 s25, s25, 256
s_waitcnt vmcnt(16)
s_barrier
s_add_u32 m0, s28, 65536
s_nop 0
buffer_load_dwordx4 v10, s[8:11], s24 offen offset:0 lds
buffer_load_dwordx4 v11, s[8:11], s24 offen offset:1024 lds
buffer_load_dwordx4 v12, s[8:11], s24 offen offset:2048 lds
buffer_load_dwordx4 v13, s[8:11], s24 offen offset:3072 lds
s_add_u32 m0, s28, 69632
s_nop 0
buffer_load_dwordx4 v10, s[8:11], s25 offen offset:0 lds
buffer_load_dwordx4 v11, s[8:11], s25 offen offset:1024 lds
buffer_load_dwordx4 v12, s[8:11], s25 offen offset:2048 lds
buffer_load_dwordx4 v13, s[8:11], s25 offen offset:3072 lds
s_add_u32 s24, s24, 256
s_add_u32 s25, s25, 256
s_waitcnt vmcnt(16)
s_barrier
s_add_u32 m0, s28, 98304
s_nop 0
buffer_load_dwordx4 v10, s[8:11], s24 offen offset:0 lds
buffer_load_dwordx4 v11, s[8:11], s24 offen offset:1024 lds
buffer_load_dwordx4 v12, s[8:11], s24 offen offset:2048 lds
buffer_load_dwordx4 v13, s[8:11], s24 offen offset:3072 lds
s_add_u32 m0, s28, 102400
s_nop 0
buffer_load_dwordx4 v10, s[8:11], s25 offen offset:0 lds
buffer_load_dwordx4 v11, s[8:11], s25 offen offset:1024 lds
buffer_load_dwordx4 v12, s[8:11], s25 offen offset:2048 lds
buffer_load_dwordx4 v13, s[8:11], s25 offen offset:3072 lds
s_add_u32 s24, s24, 256
s_add_u32 s25, s25, 256
s_waitcnt vmcnt(16)
s_barrier
s_add_u32 m0, s28, 0
s_nop 0
buffer_load_dwordx4 v10, s[8:11], s24 offen offset:0 lds
buffer_load_dwordx4 v11, s[8:11], s24 offen offset:1024 lds
buffer_load_dwordx4 v12, s[8:11], s24 offen offset:2048 lds
buffer_load_dwordx4 v13, s[8:11], s24 offen offset:3072 lds
s_add_u32 m0, s28, 4096
s_nop 0
buffer_load_dwordx4 v10, s[8:11], s25 offen offset:0 lds
buffer_load_dwordx4 v11, s[8:11], s25 offen offset:1024 lds
buffer_load_dwordx4 v12, s[8:11], s25 offen offset:2048 lds
buffer_load_dwordx4 v13, s[8:11], s25 offen offset:3072 lds
s_add_u32 s24, s24, 256
s_add_u32 s25, s25, 256
s_waitcnt vmcnt(16)
s_barrier
s_add_u32 m0, s28, 32768
s_nop 0
buffer_load_dwordx4 v10, s[8:11], s24 offen offset:0 lds
buffer_load_dwordx4 v11, s[8:11], s24 offen offset:1024 lds
buffer_load_dwordx4 v12, s[8:11], s24 offen offset:2048 lds
buffer_load_dwordx4 v13, s[8:11], s24 offen offset:3072 lds
s_add_u32 m0, s28, 36864
s_nop 0
buffer_load_dwordx4 v10, s[8:11], s25 offen offset:0 lds
buffer_load_dwordx4 v11, s[8:11], s25 offen offset:1024 lds
buffer_load_dwordx4 v12, s[8:11], s25 offen offset:2048 lds
buffer_load_dwordx4 v13, s[8:11], s25 offen offset:3072 lds
s_add_u32 s24, s24, 256
s_add_u32 s25, s25, 256
s_waitcnt vmcnt(16)
s_barrier
s_add_u32 m0, s28, 65536
s_nop 0
buffer_load_dwordx4 v10, s[8:11], s24 offen offset:0 lds
buffer_load_dwordx4 v11, s[8:11], s24 offen offset:1024 lds
buffer_load_dwordx4 v12, s[8:11], s24 offen offset:2048 lds
buffer_load_dwordx4 v13, s[8:11], s24 offen offset:3072 lds
s_add_u32 m0, s28, 69632
s_nop 0
buffer_load_dwordx4 v10, s[8:11], s25 offen offset:0 lds
buffer_load_dwordx4 v11, s[8:11], s25 offen offset:1024 lds
buffer_load_dwordx4 v12, s[8:11], s25 offen offset:2048 lds
buffer_load_dwordx4 v13, s[8:11], s25 offen offset:3072 lds
s_add_u32 s24, s24, 256
s_add_u32 s25, s25, 256
s_waitcnt vmcnt(16)
s_barrier
s_add_u32 m0, s28, 98304
s_nop 0
buffer_load_dwordx4 v10, s[8:11], s24 offen offset:0 lds
buffer_load_dwordx4 v11, s[8:11], s24 offen offset:1024 lds
buffer_load_dwordx4 v12, s[8:11], s24 offen offset:2048 lds
buffer_load_dwordx4 v13, s[8:11], s24 offen offset:3072 lds
s_add_u32 m0, s28, 102400
s_nop 0
buffer_load_dwordx4 v10, s[8:11], s25 offen offset:0 lds
buffer_load_dwordx4 v11, s[8:11], s25 offen offset:1024 lds
buffer_load_dwordx4 v12, s[8:11], s25 offen offset:2048 lds
buffer_load_dwordx4 v13, s[8:11], s25 offen offset:3072 lds
s_add_u32 s24, s24, 256
s_add_u32 s25, s25, 256
s_waitcnt vmcnt(16)
s_barrier
s_add_u32 m0, s28, 0
s_nop 0
buffer_load_dwordx4 v10, s[8:11], s24 offen offset:0 lds
buffer_load_dwordx4 v11, s[8:11], s24 offen offset:1024 lds
buffer_load_dwordx4 v12, s[8:11], s24 offen offset:2048 lds
buffer_load_dwordx4 v13, s[8:11], s24 offen offset:3072 lds
s_add_u32 m0, s28, 4096
s_nop 0
buffer_load_dwordx4 v10, s[8:11], s25 offen offset:0 lds
buffer_load_dwordx4 v11, s[8:11], s25 offen offset:1024 lds
buffer_load_dwordx4 v12, s[8:11], s25 offen offset:2048 lds
buffer_load_dwordx4 v13, s[8:11], s25 offen offset:3072 lds
s_add_u32 s24, s24, 256
s_add_u32 s25, s25, 256
s_waitcnt vmcnt(16)
s_barrier
s_add_u32 m0, s28, 32768
s_nop 0
buffer_load_dwordx4 v10, s[8:11], s24 offen offset:0 lds
buffer_load_dwordx4 v11, s[8:11], s24 offen offset:1024 lds
buffer_load_dwordx4 v12, s[8:11], s24 offen offset:2048 lds
buffer_load_dwordx4 v13, s[8:11], s24 offen offset:3072 lds
s_add_u32 m0, s28, 36864
s_nop 0
buffer_load_dwordx4 v10, s[8:11], s25 offen offset:0 lds
buffer_load_dwordx4 v11, s[8:11], s25 offen offset:1024 lds
buffer_load_dwordx4 v12, s[8:11], s25 offen offset:2048 lds
buffer_load_dwordx4 v13, s[8:11], s25 offen offset:3072 lds
s_add_u32 s24, s24, 256
s_add_u32 s25, s25, 256
s_waitcnt vmcnt(16)
s_barrier
s_add_u32 m0, s28, 65536
s_nop 0
buffer_load_dwordx4 v10, s[8:11], s24 offen offset:0 lds
buffer_load_dwordx4 v11, s[8:11], s24 offen offset:1024 lds
buffer_load_dwordx4 v12, s[8:11], s24 offen offset:2048 lds
buffer_load_dwordx4 v13, s[8:11], s24 offen offset:3072 lds
s_add_u32 m0, s28, 69632
s_nop 0
buffer_load_dwordx4 v10, s[8:11], s25 offen offset:0 lds
buffer_load_dwordx4 v11, s[8:11], s25 offen offset:1024 lds
buffer_load_dwordx4 v12, s[8:11], s25 offen offset:2048 lds
buffer_load_dwordx4 v13, s[8:11], s25 offen offset:3072 lds
s_add_u32 s24, s24, 256
s_add_u32 s25, s25, 256
s_waitcnt vmcnt(16)
s_barrier
s_add_u32 m0, s28, 98304
s_nop 0
buffer_load_dwordx4 v10, s[8:11], s24 offen offset:0 lds
buffer_load_dwordx4 v11, s[8:11], s24 offen offset:1024 lds
buffer_load_dwordx4 v12, s[8:11], s24 offen offset:2048 lds
buffer_load_dwordx4 v13, s[8:11], s24 offen offset:3072 lds
s_add_u32 m0, s28, 102400
s_nop 0
buffer_load_dwordx4 v10, s[8:11], s25 offen offset:0 lds
buffer_load_dwordx4 v11, s[8:11], s25 offen offset:1024 lds
buffer_load_dwordx4 v12, s[8:11], s25 offen offset:2048 lds
buffer_load_dwordx4 v13, s[8:11], s25 offen offset:3072 lds
s_add_u32 s24, s24, 256
s_add_u32 s25, s25, 256
s_waitcnt vmcnt(16)
s_barrier
s_add_u32 m0, s28, 0
s_nop 0
buffer_load_dwordx4 v10, s[8:11], s24 offen offset:0 lds
buffer_load_dwordx4 v11, s[8:11], s24 offen offset:1024 lds
buffer_load_dwordx4 v12, s[8:11], s24 offen offset:2048 lds
buffer_load_dwordx4 v13, s[8:11], s24 offen offset:3072 lds
s_add_u32 m0, s28, 4096
s_nop 0
buffer_load_dwordx4 v10, s[8:11], s25 offen offset:0 lds
buffer_load_dwordx4 v11, s[8:11], s25 offen offset:1024 lds
buffer_load_dwordx4 v12, s[8:11], s25 offen offset:2048 lds
buffer_load_dwordx4 v13, s[8:11], s25 offen offset:3072 lds
s_add_u32 s24, s24, 256
s_add_u32 s25, s25, 256
s_waitcnt vmcnt(16)
s_barrier
s_add_u32 m0, s28, 32768
s_nop 0
buffer_load_dwordx4 v10, s[8:11], s24 offen offset:0 lds
buffer_load_dwordx4 v11, s[8:11], s24 offen offset:1024 lds
buffer_load_dwordx4 v12, s[8:11], s24 offen offset:2048 lds
buffer_load_dwordx4 v13, s[8:11], s24 offen offset:3072 lds
s_add_u32 m0, s28, 36864
s_nop 0
buffer_load_dwordx4 v10, s[8:11], s25 offen offset:0 lds
buffer_load_dwordx4 v11, s[8:11], s25 offen offset:1024 lds
buffer_load_dwordx4 v12, s[8:11], s25 offen offset:2048 lds
buffer_load_dwordx4 v13, s[8:11], s25 offen offset:3072 lds
s_add_u32 s24, s24, 256
s_add_u32 s25, s25, 256
s_waitcnt vmcnt(16)
s_barrier
s_add_u32 m0, s28, 65536
s_nop 0
buffer_load_dwordx4 v10, s[8:11], s24 offen offset:0 lds
buffer_load_dwordx4 v11, s[8:11], s24 offen offset:1024 lds
buffer_load_dwordx4 v12, s[8:11], s24 offen offset:2048 lds
buffer_load_dwordx4 v13, s[8:11], s24 offen offset:3072 lds
s_add_u32 m0, s28, 69632
s_nop 0
buffer_load_dwordx4 v10, s[8:11], s25 offen offset:0 lds
buffer_load_dwordx4 v11, s[8:11], s25 offen offset:1024 lds
buffer_load_dwordx4 v12, s[8:11], s25 offen offset:2048 lds
buffer_load_dwordx4 v13, s[8:11], s25 offen offset:3072 lds
s_add_u32 s24, s24, 256
s_add_u32 s25, s25, 256
s_waitcnt vmcnt(16)
s_barrier
s_waitcnt vmcnt(8)
s_barrier
s_waitcnt vmcnt(0)
s_barrier
L_s2_done:
s_endpgm
.section .rodata,"a"
.p2align 6
.amdhsa_kernel prep_kernel
  .amdhsa_next_free_vgpr 80
  .amdhsa_next_free_sgpr 100
  .amdhsa_accum_offset 80
  .amdhsa_group_segment_fixed_size 0
  .amdhsa_kernarg_size 96
  .amdhsa_user_sgpr_count 2
  .amdhsa_user_sgpr_kernarg_segment_ptr 1
  .amdhsa_system_sgpr_workgroup_id_x 1
  .amdhsa_float_denorm_mode_32 3
.end_amdhsa_kernel
.p2align 6
.amdhsa_kernel stage1_kernel
  .amdhsa_next_free_vgpr 200
  .amdhsa_next_free_sgpr 100
  .amdhsa_accum_offset 200
  .amdhsa_group_segment_fixed_size 0
  .amdhsa_kernarg_size 96
  .amdhsa_user_sgpr_count 2
  .amdhsa_user_sgpr_kernarg_segment_ptr 1
  .amdhsa_system_sgpr_workgroup_id_x 1
  .amdhsa_float_denorm_mode_32 3
.end_amdhsa_kernel
.p2align 6
.amdhsa_kernel stage2_kernel
  .amdhsa_next_free_vgpr 200
  .amdhsa_next_free_sgpr 100
  .amdhsa_accum_offset 200
  .amdhsa_group_segment_fixed_size 0
  .amdhsa_kernarg_size 96
  .amdhsa_user_sgpr_count 2
  .amdhsa_user_sgpr_kernarg_segment_ptr 1
  .amdhsa_system_sgpr_workgroup_id_x 1
  .amdhsa_float_denorm_mode_32 3
.end_amdhsa_kernel
```
